```python
import torch

def _softmax(x, axis=-1):
    return torch.softmax(x, dim=axis)
def _gelu(x):
    return torch.nn.functional.gelu(x, approximate="tanh")
def _silu(x):
    return torch.nn.functional.silu(x)
def _sigmoid(x):
    return torch.sigmoid(x)
def _layernorm(x, axis=-1, eps=1e-5):
    m = x.mean(dim=axis, keepdim=True)
    v = x.var(dim=axis, keepdim=True, unbiased=False)
    return (x - m) / torch.sqrt(v + eps)
def _scatter_add(tgt, idx, src, axis=0):
    return tgt.clone().index_add_(axis, idx, src)
def _segment_sum(src, seg, n):
    out = torch.zeros((n,) + src.shape[1:], dtype=src.dtype)
    return out.index_add_(0, seg, src)
def _pad(x, pw):
    flat = tuple(v for pair in reversed(pw) for v in pair)
    return torch.nn.functional.pad(x, flat)

kernel_name = 'standalone__edge_featured_mpnn_gatedgcn__graph'

def setup_inputs():

    _w = (lambda a: (lambda t: t.to(torch.bfloat16) if t.is_floating_point() else t)(torch.as_tensor(a)))
    N, deg, D, De = 10000, 32, 128, max(4, 1)
    E = N * deg
    return {
        "x": _w((lambda *s: torch.randn(*s, dtype=torch.bfloat16) * 0.4)(N, D)),
        "e_attr": _w((lambda *s: torch.randn(*s, dtype=torch.bfloat16) * 0.8)(E, De)),
        "src": _w((lambda lo, hi, *s: torch.randint(lo, hi, s))(0, N, E).to(torch.int64)),
        "dst": _w((lambda lo, hi, *s: torch.randint(lo, hi, s))(0, N, E).to(torch.int64)),
        "w_a": _w((lambda *s: torch.randn(*s, dtype=torch.bfloat16) * 0.4)(D, D)),
        "w_b": _w((lambda *s: torch.randn(*s, dtype=torch.bfloat16) * 0.4)(D, D)),
        "w_c": _w((lambda *s: torch.randn(*s, dtype=torch.bfloat16) * 0.8)(De, D)),
        "w_u": _w((lambda *s: torch.randn(*s, dtype=torch.bfloat16) * 0.05)(D, D)),
        "w_v": _w((lambda *s: torch.randn(*s, dtype=torch.bfloat16) * 0.05)(D, D)),
    }

def reference(x, e_attr, src, dst, w_a, w_b, w_c, w_u, w_v):
    N, D = x.shape
    hv = x @ w_v
    g = x[dst] @ w_a + x[src] @ w_b + e_attr @ w_c
    eta = _sigmoid(g)
    denom = _segment_sum(eta, dst, N) + 1e-6
    eta_n = eta / denom[dst]
    agg = _segment_sum(eta_n * hv[src], dst, N)
    z = x @ w_u + agg
    relu_z = torch.where(z > 0, z, 0 * z)
    return x + relu_z
```

```asm
; @launch grid=(256,1,1) block=(1024,1,1) lds=163360
.amdgcn_target "amdgcn-amd-amdhsa--gfx950"
.text
.globl standalone__edge_featured_mpnn_gatedgcn__graph_kernel
.p2align 8
.type standalone__edge_featured_mpnn_gatedgcn__graph_kernel,@function
standalone__edge_featured_mpnn_gatedgcn__graph_kernel:
    s_cmp_ge_u32 s2, 256
    s_cbranch_scc1 k_exit
    s_load_dwordx8 s[8:15], s[0:1], 0
    s_load_dwordx16 s[60:75], s[0:1], 32
    s_mov_b32 s100, 1
    s_mov_b32 s99, 0x1000000
    s_mov_b32 s98, 1
    v_lshrrev_b32 v1, 6, v0
    v_and_b32 v3, 63, v0
    v_readfirstlane_b32 s4, v1
    s_bfe_u32 s3, s2, 0x20001
    s_lshl_b32 s3, s3, 5
    s_lshr_b32 s78, s2, 3
    s_add_u32 s3, s3, s78
    s_and_b32 s5, s2, 1
    s_mul_i32 s6, s3, 625
    s_add_u32 s7, s6, 632
    s_add_u32 s6, s6, 7
    s_lshr_b32 s6, s6, 3
    s_lshr_b32 s7, s7, 3
    s_sub_u32 s7, s7, s6
    s_lshl_b32 s6, s6, 8
    s_lshl_b32 s22, s5, 7
    v_mov_b32 v124, 163312
    v_mov_b32 v123, 1
    v_mov_b64 v[100:101], -1
    v_mov_b64 v[36:37], 0
    v_mov_b64 v[38:39], 0
    s_cmp_ge_u32 s4, 5
    s_cbranch_scc1 k_notbin
    v_lshlrev_b32 v1, 4, v0
    v_lshlrev_b32 v2, 5, v0
    v_add_u32 v34, 161536, v1
    v_cmp_gt_u32 vcc, 114, v0
    s_and_saveexec_b64 s[20:21], vcc
    ds_write_b128 v34, v[36:39]
    s_mov_b64 exec, s[20:21]
    v_lshlrev_b32 v34, 3, v3
    v_add_u32 v35, 153600, v34
    ds_write_b64 v35, v[36:37]
    s_mul_i32 s20, s2, 5120
    s_mul_i32 s21, s2, 10240
    s_cmp_ge_u32 s2, 250
    s_cbranch_scc1 k_nobin
    s_waitcnt lgkmcnt(0)
    s_add_u32 s24, s14, s20
    s_addc_u32 s25, s15, 0
    s_mov_b32 s26, 5120
    s_mov_b32 s27, 0x00020000
    buffer_load_dwordx4 v[4:7], v1, s[24:27], 0 offen
    s_add_u32 s28, s12, s20
    s_addc_u32 s29, s13, 0
    s_mov_b32 s30, 5120
    s_mov_b32 s31, 0x00020000
    s_add_u32 s32, s10, s21
    s_addc_u32 s33, s11, 0
    s_mov_b32 s34, 10240
    s_mov_b32 s35, 0x00020000
    buffer_load_dwordx4 v[8:11], v1, s[28:31], 0 offen
    buffer_load_dwordx4 v[12:15], v2, s[32:35], 0 offen
    buffer_load_dwordx4 v[16:19], v2, s[32:35], 0 offen offset:16
    s_barrier
    s_setprio 2
    s_mul_i32 s20, s2, 15360
    s_add_u32 s20, s20, 5390336
    s_add_u32 s36, s74, s20
    s_addc_u32 s37, s75, 0
    s_mov_b32 s38, 15360
    s_mov_b32 s39, 0x00020000
    s_lshl_b32 s20, s2, 10
    s_add_u32 s20, s20, 5128192
    s_add_u32 s40, s74, s20
    s_addc_u32 s41, s75, 0
    s_mov_b32 s42, 1024
    s_mov_b32 s43, 0x00020000
    s_mov_b32 s17, 214749
    s_movk_i32 s18, 625
    s_mov_b32 s19, 153600
    s_lshl_b32 s20, s4, 9
    s_add_u32 s20, s20, 150528
    v_add_u32 v33, s20, v34
    s_sub_u32 s20, s20, 153600
    v_mov_b32 v40, 135168
    s_waitcnt vmcnt(3)
    v_mul_u32_u24 v20, s17, v4
    v_mul_u32_u24 v21, s17, v5
    v_mul_u32_u24 v22, s17, v6
    v_mul_u32_u24 v23, s17, v7
    v_lshrrev_b32 v20, 24, v20
    v_lshrrev_b32 v21, 24, v21
    v_lshrrev_b32 v22, 24, v22
    v_lshrrev_b32 v23, 24, v23
    v_lshl_add_u32 v28, v20, 2, s19
    ds_add_rtn_u32 v24, v28, v123
    v_lshl_add_u32 v29, v21, 2, s19
    ds_add_rtn_u32 v25, v29, v123
    v_lshl_add_u32 v30, v22, 2, s19
    ds_add_rtn_u32 v26, v30, v123
    v_lshl_add_u32 v31, v23, 2, s19
    ds_add_rtn_u32 v27, v31, v123
    s_waitcnt lgkmcnt(0)
    s_mov_b64 exec, 1
    ds_add_rtn_u32 v125, v124, v123
    s_mov_b64 exec, -1
    v_mad_u32_u24 v20, v20, s18, 7
    v_mad_u32_u24 v21, v21, s18, 7
    v_mad_u32_u24 v22, v22, s18, 7
    v_mad_u32_u24 v23, v23, s18, 7
    v_lshrrev_b32 v20, 3, v20
    v_lshrrev_b32 v21, 3, v21
    v_lshrrev_b32 v22, 3, v22
    v_lshrrev_b32 v23, 3, v23
    v_sub_u32 v4, v4, v20
    v_sub_u32 v5, v5, v21
    v_sub_u32 v6, v6, v22
    v_sub_u32 v7, v7, v23
    v_add_u32 v28, s20, v28
    v_add_u32 v29, s20, v29
    v_add_u32 v30, s20, v30
    v_add_u32 v31, s20, v31
    s_waitcnt lgkmcnt(0)
    v_readfirstlane_b32 s16, v125
    s_cmp_eq_u32 s16, 4
    s_cbranch_scc1 k_sp0x
k_sp0:
    ds_read_b32 v125, v124 offset:0
    s_waitcnt lgkmcnt(0)
    v_readfirstlane_b32 s16, v125
    s_sub_u32 s99, s99, 1
    s_cbranch_scc1 k_exit
    s_cmp_lt_u32 s16, 5
    s_cbranch_scc1 k_sp0
k_sp0x:
    ds_read_b64 v[36:37], v35
    s_waitcnt lgkmcnt(0)
    v_add_u32 v38, v36, v37
    v_mov_b32 v39, v38
    s_nop 1
    v_add_u32_dpp v38, v38, v38 row_shr:1 row_mask:0xf bank_mask:0xf bound_ctrl:0
    s_nop 1
    v_add_u32_dpp v38, v38, v38 row_shr:2 row_mask:0xf bank_mask:0xf bound_ctrl:0
    s_nop 1
    v_add_u32_dpp v38, v38, v38 row_shr:4 row_mask:0xf bank_mask:0xf bound_ctrl:0
    s_nop 1
    v_add_u32_dpp v38, v38, v38 row_shr:8 row_mask:0xf bank_mask:0xf bound_ctrl:0
    s_nop 1
    v_add_u32_dpp v38, v38, v38 row_bcast:15 row_mask:0xa bank_mask:0xf
    s_nop 1
    v_add_u32_dpp v38, v38, v38 row_bcast:31 row_mask:0xc bank_mask:0xf
    v_sub_u32 v38, v38, v39
    v_add_u32 v39, v38, v36
    ds_write_b64 v33, v[38:39]
    ds_read_b32 v20, v28
    ds_read_b32 v21, v29
    ds_read_b32 v22, v30
    ds_read_b32 v23, v31
    v_lshl_or_b32 v44, v36, 11, v38
    v_lshl_or_b32 v46, v37, 11, v39
    v_or_b32 v44, 0xa9400000, v44
    v_or_b32 v46, 0xa9400000, v46
    s_waitcnt vmcnt(0)
    v_lshl_or_b32 v8, v4, 16, v8
    v_lshl_or_b32 v9, v5, 16, v9
    v_lshl_or_b32 v10, v6, 16, v10
    v_lshl_or_b32 v11, v7, 16, v11
    s_waitcnt lgkmcnt(0)
    v_add_u32 v20, v20, v24
    v_mad_u32_u24 v20, v20, 12, v40
    ds_write2_b32 v20, v12, v13 offset0:0 offset1:1
    ds_write_b32 v20, v8 offset:8
    v_add_u32 v21, v21, v25
    v_mad_u32_u24 v21, v21, 12, v40
    ds_write2_b32 v21, v14, v15 offset0:0 offset1:1
    ds_write_b32 v21, v9 offset:8
    v_add_u32 v22, v22, v26
    v_mad_u32_u24 v22, v22, 12, v40
    ds_write2_b32 v22, v16, v17 offset0:0 offset1:1
    ds_write_b32 v22, v10 offset:8
    v_add_u32 v23, v23, v27
    v_mad_u32_u24 v23, v23, 12, v40
    ds_write2_b32 v23, v18, v19 offset0:0 offset1:1
    ds_write_b32 v23, v11 offset:8
    v_add_u32 v2, 5120, v1
    v_add_u32 v32, 10240, v1
    v_add_u32 v40, v40, v1
    s_waitcnt lgkmcnt(0)
    s_mov_b64 exec, 1
    ds_add_rtn_u32 v125, v124, v123 offset:4
    s_waitcnt lgkmcnt(0)
    v_readfirstlane_b32 s16, v125
    s_cmp_eq_u32 s16, 4
    s_cbranch_scc1 k_sp1x
k_sp1:
    ds_read_b32 v125, v124 offset:4
    s_waitcnt lgkmcnt(0)
    v_readfirstlane_b32 s16, v125
    s_sub_u32 s99, s99, 1
    s_cbranch_scc1 k_exit
    s_cmp_lt_u32 s16, 5
    s_cbranch_scc1 k_sp1
k_sp1x:
    s_mov_b64 exec, -1
    ds_read_b128 v[4:7], v40 offset:0
    ds_read_b128 v[8:11], v40 offset:5120
    ds_read_b128 v[12:15], v40 offset:10240
    s_waitcnt lgkmcnt(2)
    buffer_store_dwordx4 v[4:7], v1, s[36:39], 0 offen sc1
    s_waitcnt lgkmcnt(1)
    buffer_store_dwordx4 v[8:11], v2, s[36:39], 0 offen sc1
    s_waitcnt lgkmcnt(0)
    buffer_store_dwordx4 v[12:15], v32, s[36:39], 0 offen sc1
    v_lshlrev_b32 v34, 4, v3
k_sp2f:
    ds_read_b32 v125, v124 offset:28
    s_waitcnt lgkmcnt(0)
    v_readfirstlane_b32 s16, v125
    s_sub_u32 s99, s99, 1
    s_cbranch_scc1 k_exit
    s_cmp_lt_u32 s16, 1
    s_cbranch_scc1 k_sp2f
    ds_read_b32 v45, v124 offset:24
    ds_read_b32 v47, v124 offset:24
    s_waitcnt vmcnt(0)
    s_mov_b64 exec, 1
    ds_add_rtn_u32 v125, v124, v123 offset:8
    s_waitcnt lgkmcnt(0)
    v_readfirstlane_b32 s16, v125
    s_mov_b64 exec, -1
    s_cmp_lg_u32 s16, 4
    s_cbranch_scc1 k_p2
    s_branch k_hdr1
k_hdr:
k_sp2:
    ds_read_b32 v125, v124 offset:28
    s_waitcnt lgkmcnt(0)
    v_readfirstlane_b32 s16, v125
    s_sub_u32 s99, s99, 1
    s_cbranch_scc1 k_exit
    s_cmp_lt_u32 s16, 1
    s_cbranch_scc1 k_sp2
    ds_read_b32 v45, v124 offset:24
    ds_read_b32 v47, v124 offset:24
    s_waitcnt lgkmcnt(0)
k_hdr1:
    buffer_store_dwordx4 v[44:47], v34, s[40:43], 0 offen sc1
    s_waitcnt vmcnt(0)
    s_mov_b64 exec, 1
    ds_add_u32 v124, v123 offset:36
    s_mov_b64 exec, -1
    s_branch k_p2
k_nobin:
    s_waitcnt lgkmcnt(0)
    s_lshl_b32 s20, s2, 10
    s_add_u32 s20, s20, 5128192
    s_add_u32 s40, s74, s20
    s_addc_u32 s41, s75, 0
    s_mov_b32 s42, 1024
    s_mov_b32 s43, 0x00020000
    v_mov_b32 v44, 0xa9400000
    v_mov_b32 v46, 0xa9400000
    v_lshlrev_b32 v34, 4, v3
    s_barrier
    s_mov_b64 exec, 1
    ds_add_u32 v124, v123
    ds_add_u32 v124, v123 offset:4
    ds_add_u32 v124, v123 offset:8
    s_mov_b64 exec, -1
    s_cmp_lg_u32 s4, 0
    s_cbranch_scc1 k_p2
k_spn:
    s_sleep 2
    ds_read_b32 v125, v124 offset:16
    s_waitcnt lgkmcnt(0)
    v_readfirstlane_b32 s16, v125
    s_sub_u32 s99, s99, 1
    s_cbranch_scc1 k_exit
    s_cmp_lt_u32 s16, 5
    s_cbranch_scc1 k_spn
    s_branch k_hdr
k_notbin:
    s_cmp_eq_u32 s4, 15
    s_cbranch_scc1 k_w15
    s_sub_u32 s23, s4, 5
    s_cmp_ge_u32 s4, 10
    s_cselect_b32 s21, 1, 0
    s_mul_i32 s20, s21, 5
    s_sub_u32 s23, s23, s20
    s_mul_i32 s19, s21, 40960
    s_add_u32 s19, s19, 40960
    v_lshrrev_b32 v4, 4, v3
    v_and_b32 v5, 15, v3
    v_xor_b32 v16, v5, v4
    v_lshlrev_b32 v16, 4, v16
    v_lshl_or_b32 v6, v4, 8, v16
    s_lshl_b32 s20, s21, 7
    v_xor_b32 v6, s20, v6
    v_lshrrev_b32 v8, 3, v3
    v_and_b32 v7, 7, v3
    v_lshlrev_b32 v7, 4, v7
    v_lshl_or_b32 v7, v8, 8, v7
    v_and_b32 v8, 16, v3
    v_lshlrev_b32 v8, 1, v8
    v_xor_b32 v7, v7, v8
    s_lshl_b32 s17, s23, 12
    s_add_u32 s20, s17, 114688
    v_lshl_or_b32 v8, v5, 8, v16
    v_add_u32 v8, s20, v8
    v_xor_b32 v9, 64, v8
    v_xor_b32 v10, 128, v8
    v_xor_b32 v11, 192, v8
    v_bfe_u32 v13, v3, 2, 2
    v_lshl_add_u32 v12, v4, 3, v13
    v_bfe_u32 v13, v3, 3, 2
    v_lshlrev_b32 v13, 5, v13
    v_lshl_or_b32 v12, v12, 7, v13
    v_and_b32 v13, 3, v3
    v_lshl_or_b32 v12, v13, 3, v12
    v_add_u32 v12, s19, v12
    v_xor_b32 v13, 32, v12
    v_xor_b32 v14, 64, v12
    v_xor_b32 v15, 96, v12
    s_sub_u32 s18, 2560000, s6
    s_sub_u32 s20, 32768, s22
    s_waitcnt lgkmcnt(0)
    s_cmp_eq_u32 s21, 0
    s_cselect_b32 s28, s62, s60
    s_cselect_b32 s29, s63, s61
    s_cselect_b32 s32, s68, s66
    s_cselect_b32 s33, s69, s67
    s_add_u32 s28, s28, s22
    s_addc_u32 s29, s29, 0
    s_mov_b32 s30, s20
    s_mov_b32 s31, 0x00020000
    s_add_u32 s32, s32, s22
    s_addc_u32 s33, s33, 0
    s_mov_b32 s34, s20
    s_mov_b32 s35, 0x00020000
    s_add_u32 s24, s8, s6
    s_addc_u32 s25, s9, 0
    s_mov_b32 s26, s18
    s_mov_b32 s27, 0x00020000
    s_lshl_b32 s40, s21, 11
    s_add_u32 s40, s40, s17
    s_barrier
    s_add_u32 s41, s40, 0
    s_add_u32 m0, s41, 114688
    v_xor_b32 v17, 0, v6
    buffer_load_dwordx4 v17, s[24:27], s41 offen lds
    s_add_u32 s41, s40, 1024
    s_add_u32 m0, s41, 114688
    v_xor_b32 v17, 64, v6
    buffer_load_dwordx4 v17, s[24:27], s41 offen lds
    s_cmp_eq_u32 s21, 0
    s_cbranch_scc1 k_wnow
    s_waitcnt vmcnt(0) lgkmcnt(0)
    s_mov_b64 exec, 1
    ds_add_u32 v124, v123 offset:12
k_spw:
    s_sleep 1
    ds_read_b32 v125, v124 offset:0
    s_waitcnt lgkmcnt(0)
    v_readfirstlane_b32 s16, v125
    s_sub_u32 s99, s99, 1
    s_cbranch_scc1 k_exit
    s_cmp_lt_u32 s16, 5
    s_cbranch_scc1 k_spw
    s_mov_b64 exec, -1
k_wnow:
    s_add_u32 s41, s23, 0
    s_and_b32 s42, s41, 1
    s_lshl_b32 s42, s42, 6
    s_lshl_b32 s43, s41, 11
    s_lshl_b32 s41, s41, 10
    v_xor_b32 v17, s42, v7
    s_add_u32 s41, s41, s19
    s_mov_b32 m0, s41
    s_nop 0
    buffer_load_dwordx4 v17, s[28:31], s43 offen lds
    s_add_u32 m0, s41, 16384
    s_nop 0
    buffer_load_dwordx4 v17, s[32:35], s43 offen lds
    s_add_u32 s41, s23, 5
    s_and_b32 s42, s41, 1
    s_lshl_b32 s42, s42, 6
    s_lshl_b32 s43, s41, 11
    s_lshl_b32 s41, s41, 10
    v_xor_b32 v17, s42, v7
    s_add_u32 s41, s41, s19
    s_mov_b32 m0, s41
    s_nop 0
    buffer_load_dwordx4 v17, s[28:31], s43 offen lds
    s_add_u32 m0, s41, 16384
    s_nop 0
    buffer_load_dwordx4 v17, s[32:35], s43 offen lds
    s_add_u32 s41, s23, 10
    s_and_b32 s42, s41, 1
    s_lshl_b32 s42, s42, 6
    s_lshl_b32 s43, s41, 11
    s_lshl_b32 s41, s41, 10
    v_xor_b32 v17, s42, v7
    s_add_u32 s41, s41, s19
    s_mov_b32 m0, s41
    s_nop 0
    buffer_load_dwordx4 v17, s[28:31], s43 offen lds
    s_add_u32 m0, s41, 16384
    s_nop 0
    buffer_load_dwordx4 v17, s[32:35], s43 offen lds
    s_cmp_ge_u32 s23, 1
    s_cbranch_scc1 k_dmadone
    s_add_u32 s41, s23, 15
    s_and_b32 s42, s41, 1
    s_lshl_b32 s42, s42, 6
    s_lshl_b32 s43, s41, 11
    s_lshl_b32 s41, s41, 10
    v_xor_b32 v17, s42, v7
    s_add_u32 s41, s41, s19
    s_mov_b32 m0, s41
    s_nop 0
    buffer_load_dwordx4 v17, s[28:31], s43 offen lds
    s_add_u32 m0, s41, 16384
    s_nop 0
    buffer_load_dwordx4 v17, s[32:35], s43 offen lds
k_dmadone:
    s_mul_i32 s40, s5, 2564096
    s_add_u32 s40, s40, s6
    s_add_u32 s40, s40, s17
    s_lshl_b32 s41, s7, 8
    s_sub_i32 s41, s41, s17
    s_min_i32 s41, s41, 4096
    s_add_u32 s36, s74, s40
    s_addc_u32 s37, s75, 0
    s_mov_b32 s38, s41
    s_mov_b32 s39, 0x00020000
    v_lshlrev_b32 v6, 10, v4
    v_lshl_or_b32 v6, v5, 4, v6
    s_lshl_b32 s40, s17, 1
    v_lshlrev_b32 v7, 11, v4
    v_lshl_or_b32 v7, v5, 4, v7
    v_add_u32 v7, s40, v7
    s_mov_b32 s18, 0xbfb8aa3b
    s_mov_b32 s19, 0xbfb8aa3b
    s_mul_i32 s40, s21, 20
    v_add_u32 v17, s40, v124
    s_waitcnt vmcnt(0)
    s_mov_b64 exec, 1
    ds_add_u32 v17, v123 offset:12
k_sp3:
    s_sleep 1
    ds_read_b32 v125, v124 offset:12
    s_waitcnt lgkmcnt(0)
    v_readfirstlane_b32 s16, v125
    s_sub_u32 s99, s99, 1
    s_cbranch_scc1 k_exit
    s_cmp_lt_u32 s16, 10
    s_cbranch_scc1 k_sp3
    s_cmp_eq_u32 s21, 0
    s_cbranch_scc1 k_g0
k_sp3b:
    s_sleep 1
    ds_read_b32 v125, v124 offset:32
    s_waitcnt lgkmcnt(0)
    v_readfirstlane_b32 s16, v125
    s_sub_u32 s99, s99, 1
    s_cbranch_scc1 k_exit
    s_cmp_lt_u32 s16, 5
    s_cbranch_scc1 k_sp3b
    s_branch k_g1
k_g0:
    s_setprio 1
k_g1:
    s_mov_b64 exec, -1
    ds_read_b128 v[16:19], v8
    ds_read_b128 v[20:23], v9
    ds_read_b128 v[24:27], v10
    ds_read_b128 v[28:31], v11
    ds_read_b64_tr_b16 v[32:33], v12 offset:0
    ds_read_b64_tr_b16 v[34:35], v12 offset:512
    ds_read_b64_tr_b16 v[36:37], v13 offset:0
    ds_read_b64_tr_b16 v[38:39], v13 offset:512
    ds_read_b64_tr_b16 v[40:41], v14 offset:0
    ds_read_b64_tr_b16 v[42:43], v14 offset:512
    ds_read_b64_tr_b16 v[44:45], v15 offset:0
    ds_read_b64_tr_b16 v[46:47], v15 offset:512
    ds_read_b64_tr_b16 v[48:49], v12 offset:16384
    ds_read_b64_tr_b16 v[50:51], v12 offset:16896
    s_waitcnt lgkmcnt(10)
    ds_read_b64_tr_b16 v[52:53], v13 offset:16384
    ds_read_b64_tr_b16 v[54:55], v13 offset:16896
    ds_read_b64_tr_b16 v[56:57], v14 offset:16384
    ds_read_b64_tr_b16 v[58:59], v14 offset:16896
    s_waitcnt lgkmcnt(12)
    v_mfma_f32_16x16x32_bf16 v[64:67], v[16:19], v[32:35], 0
    ds_read_b64_tr_b16 v[60:61], v15 offset:16384
    ds_read_b64_tr_b16 v[62:63], v15 offset:16896
    s_waitcnt lgkmcnt(12)
    v_mfma_f32_16x16x32_bf16 v[68:71], v[16:19], v[36:39], 0
    ds_read_b64_tr_b16 v[32:33], v12 offset:4096
    ds_read_b64_tr_b16 v[34:35], v12 offset:4608
    s_waitcnt lgkmcnt(12)
    v_mfma_f32_16x16x32_bf16 v[72:75], v[16:19], v[40:43], 0
    ds_read_b64_tr_b16 v[36:37], v13 offset:4096
    ds_read_b64_tr_b16 v[38:39], v13 offset:4608
    s_waitcnt lgkmcnt(12)
    v_mfma_f32_16x16x32_bf16 v[76:79], v[16:19], v[44:47], 0
    ds_read_b64_tr_b16 v[40:41], v14 offset:4096
    ds_read_b64_tr_b16 v[42:43], v14 offset:4608
    s_waitcnt lgkmcnt(12)
    v_mfma_f32_16x16x32_bf16 v[80:83], v[16:19], v[48:51], 0
    ds_read_b64_tr_b16 v[44:45], v15 offset:4096
    ds_read_b64_tr_b16 v[46:47], v15 offset:4608
    s_waitcnt lgkmcnt(12)
    v_mfma_f32_16x16x32_bf16 v[84:87], v[16:19], v[52:55], 0
    ds_read_b64_tr_b16 v[48:49], v12 offset:20480
    ds_read_b64_tr_b16 v[50:51], v12 offset:20992
    s_waitcnt lgkmcnt(12)
    v_mfma_f32_16x16x32_bf16 v[88:91], v[16:19], v[56:59], 0
    ds_read_b64_tr_b16 v[52:53], v13 offset:20480
    ds_read_b64_tr_b16 v[54:55], v13 offset:20992
    s_waitcnt lgkmcnt(12)
    v_mfma_f32_16x16x32_bf16 v[92:95], v[16:19], v[60:63], 0
    ds_read_b64_tr_b16 v[56:57], v14 offset:20480
    ds_read_b64_tr_b16 v[58:59], v14 offset:20992
    s_waitcnt lgkmcnt(12)
    v_mfma_f32_16x16x32_bf16 v[64:67], v[20:23], v[32:35], v[64:67]
    ds_read_b64_tr_b16 v[60:61], v15 offset:20480
    ds_read_b64_tr_b16 v[62:63], v15 offset:20992
    s_waitcnt lgkmcnt(12)
    v_mfma_f32_16x16x32_bf16 v[68:71], v[20:23], v[36:39], v[68:71]
    ds_read_b64_tr_b16 v[32:33], v12 offset:8192
    ds_read_b64_tr_b16 v[34:35], v12 offset:8704
    s_waitcnt lgkmcnt(12)
    v_mfma_f32_16x16x32_bf16 v[72:75], v[20:23], v[40:43], v[72:75]
    ds_read_b64_tr_b16 v[36:37], v13 offset:8192
    ds_read_b64_tr_b16 v[38:39], v13 offset:8704
    s_waitcnt lgkmcnt(12)
    v_mfma_f32_16x16x32_bf16 v[76:79], v[20:23], v[44:47], v[76:79]
    ds_read_b64_tr_b16 v[40:41], v14 offset:8192
    ds_read_b64_tr_b16 v[42:43], v14 offset:8704
    s_waitcnt lgkmcnt(12)
    v_mfma_f32_16x16x32_bf16 v[80:83], v[20:23], v[48:51], v[80:83]
    ds_read_b64_tr_b16 v[44:45], v15 offset:8192
    ds_read_b64_tr_b16 v[46:47], v15 offset:8704
    s_waitcnt lgkmcnt(12)
    v_mfma_f32_16x16x32_bf16 v[84:87], v[20:23], v[52:55], v[84:87]
    ds_read_b64_tr_b16 v[48:49], v12 offset:24576
    ds_read_b64_tr_b16 v[50:51], v12 offset:25088
    s_waitcnt lgkmcnt(12)
    v_mfma_f32_16x16x32_bf16 v[88:91], v[20:23], v[56:59], v[88:91]
    ds_read_b64_tr_b16 v[52:53], v13 offset:24576
    ds_read_b64_tr_b16 v[54:55], v13 offset:25088
    s_waitcnt lgkmcnt(12)
    v_mfma_f32_16x16x32_bf16 v[92:95], v[20:23], v[60:63], v[92:95]
    ds_read_b64_tr_b16 v[56:57], v14 offset:24576
    ds_read_b64_tr_b16 v[58:59], v14 offset:25088
    s_waitcnt lgkmcnt(12)
    v_mfma_f32_16x16x32_bf16 v[64:67], v[24:27], v[32:35], v[64:67]
    ds_read_b64_tr_b16 v[60:61], v15 offset:24576
    ds_read_b64_tr_b16 v[62:63], v15 offset:25088
    s_waitcnt lgkmcnt(12)
    v_mfma_f32_16x16x32_bf16 v[68:71], v[24:27], v[36:39], v[68:71]
    ds_read_b64_tr_b16 v[32:33], v12 offset:12288
    ds_read_b64_tr_b16 v[34:35], v12 offset:12800
    s_waitcnt lgkmcnt(12)
    v_mfma_f32_16x16x32_bf16 v[72:75], v[24:27], v[40:43], v[72:75]
    ds_read_b64_tr_b16 v[36:37], v13 offset:12288
    ds_read_b64_tr_b16 v[38:39], v13 offset:12800
    s_waitcnt lgkmcnt(12)
    v_mfma_f32_16x16x32_bf16 v[76:79], v[24:27], v[44:47], v[76:79]
    ds_read_b64_tr_b16 v[40:41], v14 offset:12288
    ds_read_b64_tr_b16 v[42:43], v14 offset:12800
    s_waitcnt lgkmcnt(12)
    v_mfma_f32_16x16x32_bf16 v[80:83], v[24:27], v[48:51], v[80:83]
    ds_read_b64_tr_b16 v[44:45], v15 offset:12288
    ds_read_b64_tr_b16 v[46:47], v15 offset:12800
    s_waitcnt lgkmcnt(12)
    v_mfma_f32_16x16x32_bf16 v[84:87], v[24:27], v[52:55], v[84:87]
    ds_read_b64_tr_b16 v[48:49], v12 offset:28672
    ds_read_b64_tr_b16 v[50:51], v12 offset:29184
    s_waitcnt lgkmcnt(12)
    v_mfma_f32_16x16x32_bf16 v[88:91], v[24:27], v[56:59], v[88:91]
    ds_read_b64_tr_b16 v[52:53], v13 offset:28672
    ds_read_b64_tr_b16 v[54:55], v13 offset:29184
    s_waitcnt lgkmcnt(12)
    v_mfma_f32_16x16x32_bf16 v[92:95], v[24:27], v[60:63], v[92:95]
    ds_read_b64_tr_b16 v[56:57], v14 offset:28672
    ds_read_b64_tr_b16 v[58:59], v14 offset:29184
    s_waitcnt lgkmcnt(12)
    v_mfma_f32_16x16x32_bf16 v[64:67], v[28:31], v[32:35], v[64:67]
    ds_read_b64_tr_b16 v[60:61], v15 offset:28672
    ds_read_b64_tr_b16 v[62:63], v15 offset:29184
    s_waitcnt lgkmcnt(12)
    v_mfma_f32_16x16x32_bf16 v[68:71], v[28:31], v[36:39], v[68:71]
    s_waitcnt lgkmcnt(10)
    v_mfma_f32_16x16x32_bf16 v[72:75], v[28:31], v[40:43], v[72:75]
    s_waitcnt lgkmcnt(8)
    v_mfma_f32_16x16x32_bf16 v[76:79], v[28:31], v[44:47], v[76:79]
    s_waitcnt lgkmcnt(6)
    v_mfma_f32_16x16x32_bf16 v[80:83], v[28:31], v[48:51], v[80:83]
    s_waitcnt lgkmcnt(4)
    v_mfma_f32_16x16x32_bf16 v[84:87], v[28:31], v[52:55], v[84:87]
    s_waitcnt lgkmcnt(2)
    v_mfma_f32_16x16x32_bf16 v[88:91], v[28:31], v[56:59], v[88:91]
    s_waitcnt lgkmcnt(0)
    v_mfma_f32_16x16x32_bf16 v[92:95], v[28:31], v[60:63], v[92:95]
    s_cmp_lg_u32 s21, 0
    s_cbranch_scc1 k_epiau
    s_mov_b64 exec, 1
    ds_add_u32 v124, v123 offset:16
    s_mov_b64 exec, -1
    v_pk_mul_f32 v[64:65], v[64:65], s[18:19]
    v_pk_mul_f32 v[66:67], v[66:67], s[18:19]
    v_pk_mul_f32 v[68:69], v[68:69], s[18:19]
    v_pk_mul_f32 v[70:71], v[70:71], s[18:19]
    v_pk_mul_f32 v[72:73], v[72:73], s[18:19]
    v_pk_mul_f32 v[74:75], v[74:75], s[18:19]
    v_pk_mul_f32 v[76:77], v[76:77], s[18:19]
    v_pk_mul_f32 v[78:79], v[78:79], s[18:19]
    v_cvt_pk_bf16_f32 v16, v64, v68
    v_cvt_pk_bf16_f32 v17, v72, v76
    v_cvt_pk_bf16_f32 v18, v80, v84
    v_cvt_pk_bf16_f32 v19, v88, v92
    v_cvt_pk_bf16_f32 v20, v65, v69
    v_cvt_pk_bf16_f32 v21, v73, v77
    v_cvt_pk_bf16_f32 v22, v81, v85
    v_cvt_pk_bf16_f32 v23, v89, v93
    v_cvt_pk_bf16_f32 v24, v66, v70
    v_cvt_pk_bf16_f32 v25, v74, v78
    v_cvt_pk_bf16_f32 v26, v82, v86
    v_cvt_pk_bf16_f32 v27, v90, v94
    v_cvt_pk_bf16_f32 v28, v67, v71
    v_cvt_pk_bf16_f32 v29, v75, v79
    v_cvt_pk_bf16_f32 v30, v83, v87
    v_cvt_pk_bf16_f32 v31, v91, v95
k_spbg:
    s_sleep 1
    ds_read_b32 v125, v124 offset:36
    s_waitcnt lgkmcnt(0)
    v_readfirstlane_b32 s16, v125
    s_sub_u32 s99, s99, 1
    s_cbranch_scc1 k_exit
    s_cmp_lt_u32 s16, 1
    s_cbranch_scc1 k_spbg
    buffer_store_dwordx4 v[16:19], v6, s[36:39], 0 offen offset:0 sc1
    buffer_store_dwordx4 v[20:23], v6, s[36:39], 0 offen offset:256 sc1
    buffer_store_dwordx4 v[24:27], v6, s[36:39], 0 offen offset:512 sc1
    buffer_store_dwordx4 v[28:31], v6, s[36:39], 0 offen offset:768 sc1
    s_or_b32 s40, s23, s3
    s_cmp_lg_u32 s40, 0
    s_cbranch_scc1 k_nonull
    s_mul_i32 s40, s5, 2564096
    s_add_u32 s40, s40, 2560000
    s_add_u32 s24, s74, s40
    s_addc_u32 s25, s75, 0
    s_mov_b32 s26, 256
    s_mov_b32 s27, 0x00020000
    v_mov_b32 v32, 0x7f7f7f7f
    v_mov_b32 v33, 0x7f7f7f7f
    v_mov_b32 v34, 0
    v_mov_b32 v35, 0
    v_lshlrev_b32 v7, 4, v3
    buffer_store_dwordx4 v[32:35], v7, s[24:27], 0 offen sc1
k_nonull:
    s_branch k_p2
k_epiau:
    v_mov_b32 v8, 0xc2700000
    s_nop 2
    v_fma_f32 v16, v64, s18, v8
    v_fma_f32 v17, v68, s18, v8
    v_fma_f32 v18, v72, s18, v8
    v_fma_f32 v19, v76, s18, v8
    ds_write_b128 v7, v[16:19] offset:0
    v_fma_f32 v20, v65, s18, v8
    v_fma_f32 v21, v69, s18, v8
    v_fma_f32 v22, v73, s18, v8
    v_fma_f32 v23, v77, s18, v8
    ds_write_b128 v7, v[20:23] offset:512
    v_fma_f32 v24, v66, s18, v8
    v_fma_f32 v25, v70, s18, v8
    v_fma_f32 v26, v74, s18, v8
    v_fma_f32 v27, v78, s18, v8
    ds_write_b128 v7, v[24:27] offset:1024
    v_fma_f32 v28, v67, s18, v8
    v_fma_f32 v29, v71, s18, v8
    v_fma_f32 v30, v75, s18, v8
    v_fma_f32 v31, v79, s18, v8
    ds_write_b128 v7, v[28:31] offset:1536
    v_mov_b32 v32, v80
    v_mov_b32 v33, v84
    v_mov_b32 v34, v88
    v_mov_b32 v35, v92
    ds_write_b128 v7, v[32:35] offset:256
    v_mov_b32 v36, v81
    v_mov_b32 v37, v85
    v_mov_b32 v38, v89
    v_mov_b32 v39, v93
    ds_write_b128 v7, v[36:39] offset:768
    v_mov_b32 v40, v82
    v_mov_b32 v41, v86
    v_mov_b32 v42, v90
    v_mov_b32 v43, v94
    ds_write_b128 v7, v[40:43] offset:1280
    v_mov_b32 v44, v83
    v_mov_b32 v45, v87
    v_mov_b32 v46, v91
    v_mov_b32 v47, v95
    ds_write_b128 v7, v[44:47] offset:1792
    s_branch k_p2
k_w15:
    v_lshrrev_b32 v4, 3, v3
    v_and_b32 v5, 7, v3
    v_lshlrev_b32 v5, 4, v5
    v_lshl_or_b32 v5, v4, 8, v5
    v_mov_b32 v6, 0
    s_sub_u32 s23, 1024, s22
    s_getpc_b64 s[42:43]
k_pc:
    s_mul_i32 s20, s78, 512
    s_sub_u32 s42, s42, k_pc - standalone__edge_featured_mpnn_gatedgcn__graph_kernel
    s_subb_u32 s43, s43, 0
    s_min_u32 s20, s20, k_end - standalone__edge_featured_mpnn_gatedgcn__graph_kernel - 388
    s_and_b32 s20, s20, -4
    s_add_u32 s42, s42, s20
    s_addc_u32 s43, s43, 0
    s_waitcnt lgkmcnt(0)
    s_add_u32 s76, s74, 9263104
    s_addc_u32 s77, s75, 0
    s_load_dword s101, s[76:77], 0
    s_barrier
    s_mul_i32 s38, s2, 15360
    s_add_u32 s38, s38, 5390336
    s_add_u32 s36, s74, s38
    s_addc_u32 s37, s75, 0
    s_load_dword s24, s[36:37], 0
    s_load_dword s25, s[36:37], 3836
    s_load_dword s26, s[36:37], 7672
    s_load_dword s27, s[36:37], 11508
    s_load_dword s28, s[36:37], 15344
    s_lshl_b32 s38, s2, 10
    s_add_u32 s38, s38, 5128192
    s_add_u32 s36, s74, s38
    s_addc_u32 s37, s75, 0
    s_load_dword s24, s[36:37], 0
    s_mul_i32 s38, s5, 2564096
    s_add_u32 s38, s38, s6
    s_add_u32 s36, s74, s38
    s_addc_u32 s37, s75, 0
    s_load_dword s24, s[36:37], 0
    s_load_dword s25, s[36:37], 4092
    s_load_dword s26, s[36:37], 8184
    s_load_dword s27, s[36:37], 12276
    s_load_dword s28, s[36:37], 16368
    s_load_dword s29, s[36:37], 20460
    s_add_u32 s36, s74, 9230336
    s_addc_u32 s37, s75, 0
    s_load_dword s24, s[36:37], 0
    s_load_dword s25, s[36:37], 4096
    s_load_dword s26, s[36:37], 8192
    s_load_dword s27, s[36:37], 12288
    s_load_dword s28, s[36:37], 16384
    s_load_dword s29, s[36:37], 20480
    s_load_dword s30, s[36:37], 24576
    s_load_dword s31, s[36:37], 28672
    s_load_dword s24, s[36:37], 32768
    s_mul_i32 s38, s78, 327680
    s_add_u32 s36, s74, s38
    s_addc_u32 s37, s75, 0
    s_load_dword s24, s[36:37], 0
    s_load_dword s25, s[36:37], 65536
    s_load_dword s26, s[36:37], 131072
    s_load_dword s27, s[36:37], 196608
    s_load_dword s28, s[36:37], 262144
    s_add_u32 s32, s64, s22
    s_addc_u32 s33, s65, 0
    s_mov_b32 s34, s23
    s_mov_b32 s35, 0x00020000
    s_load_dword s40, s[42:43], 0
    s_load_dword s41, s[42:43], 128
    s_load_dword s20, s[42:43], 256
    s_load_dword s21, s[42:43], 384
    s_mov_b32 m0, 153088
    s_mov_b32 exec_hi, 0
    buffer_load_dwordx4 v5, s[32:35], 0 offen lds
    s_mov_b64 exec, -1
    s_waitcnt vmcnt(0) lgkmcnt(0)
    s_add_u32 s101, s101, 1
    v_mov_b32 v10, s101
    v_mov_b32 v11, 1
    ds_write_b64 v124, v[10:11] offset:24
k_p2:
    s_setprio 0
    s_add_u32 s24, s74, 5128192
    s_addc_u32 s25, s75, 0
    s_mov_b32 s26, 262144
    s_mov_b32 s27, 0x00020000
    s_add_u32 s28, s74, 9263104
    s_addc_u32 s29, s75, 0
    s_mov_b32 s30, 64
    s_mov_b32 s31, 0x00020000
    s_add_u32 s44, s74, 5390336
    s_addc_u32 s45, s75, 0
    s_mov_b32 s46, 3840000
    s_mov_b32 s47, 0x00020000
    s_mul_i32 s20, s5, 2564096
    s_add_u32 s48, s74, s20
    s_addc_u32 s49, s75, 0
    s_and_b32 s49, s49, 0xffff
    s_or_b32 s49, s49, 0x1000000
    s_mov_b32 s50, 10001
    s_mov_b32 s51, 0x00020000
    s_add_u32 s20, s6, s22
    s_lshl_b32 s21, s7, 8
    s_sub_u32 s21, s21, s22
    s_add_u32 s52, s70, s20
    s_addc_u32 s53, s71, 0
    s_mov_b32 s54, s21
    s_mov_b32 s55, 0x00020000
    s_add_u32 s80, s74, 9230336
    s_addc_u32 s81, s75, 0
    s_mov_b32 s82, 32768
    s_mov_b32 s83, 0x00020000
    v_and_b32 v24, 3, v0
    s_movk_i32 s23, 677
    s_sub_u32 s16, s4, 5
    s_cmp_ge_u32 s16, 5
    s_cbranch_scc1 k_work
    v_mov_b32 v31, 677
    v_mov_b32 v32, 0
    s_lshl_b32 s17, s5, 7
    s_add_u32 s17, s17, s3
    s_lshl_b32 s17, s17, 7
    s_waitcnt vmcnt(0)
    s_mov_b64 exec, 1
    ds_add_rtn_u32 v125, v124, v123 offset:20
    s_waitcnt lgkmcnt(0)
    v_readfirstlane_b32 s16, v125
    s_cmp_lg_u32 s16, 4
    s_cbranch_scc1 k_nosig
k_spb:
    ds_read_b32 v125, v124 offset:28
    s_waitcnt lgkmcnt(0)
    v_readfirstlane_b32 s16, v125
    s_sub_u32 s99, s99, 1
    s_cbranch_scc1 k_exit
    s_cmp_lt_u32 s16, 1
    s_cbranch_scc1 k_spb
    ds_read_b32 v30, v124 offset:24
    s_waitcnt lgkmcnt(0)
    buffer_store_dwordx2 v[30:31], v32, s[80:83], s17 offen sc1
k_nosig:
    s_mov_b64 exec, -1
k_work:
    s_cmp_lg_u32 s4, 15
    s_cbranch_scc1 k_join
    v_lshlrev_b32 v14, 10, v3
    v_lshlrev_b32 v15, 2, v3
    v_add_u32 v15, 135168, v15
    s_lshl_b32 s16, s3, 3
    s_add_u32 s36, s16, 0x10000
    s_add_u32 s37, s16, 0x20000
    s_add_u32 s38, s16, 0x30000
    s_mov_b32 s39, s16
    s_mov_b32 s21, 0x100000
k_sp5:
    s_sleep 1
    ds_read_b32 v125, v124 offset:36
    s_waitcnt lgkmcnt(0)
    v_readfirstlane_b32 s16, v125
    s_sub_u32 s99, s99, 1
    s_cbranch_scc1 k_exit
    s_cmp_lt_u32 s16, 1
    s_cbranch_scc1 k_sp5
    s_mov_b64 s[60:61], -1
    s_mov_b64 s[62:63], -1
    s_mov_b64 s[64:65], -1
    s_mov_b64 s[66:67], -1
k_sp6:
    s_mov_b64 exec, s[60:61]
    s_cbranch_execz k_hp0
    buffer_load_dwordx2 v[16:17], v14, s[24:27], s39 offen sc1
k_hp0:
    s_mov_b64 exec, s[62:63]
    s_cbranch_execz k_hp1
    buffer_load_dwordx2 v[18:19], v14, s[24:27], s36 offen sc1
k_hp1:
    s_mov_b64 exec, s[64:65]
    s_cbranch_execz k_hp2
    buffer_load_dwordx2 v[20:21], v14, s[24:27], s37 offen sc1
k_hp2:
    s_mov_b64 exec, s[66:67]
    s_cbranch_execz k_hp3
    buffer_load_dwordx2 v[22:23], v14, s[24:27], s38 offen sc1
k_hp3:
    s_mov_b64 exec, -1
    s_waitcnt vmcnt(0)
    v_lshrrev_b32 v26, 22, v16
    v_cmp_ne_u32 vcc, s101, v17
    v_cmp_ne_u32 s[16:17], s23, v26
    s_or_b64 s[60:61], vcc, s[16:17]
    v_lshrrev_b32 v26, 22, v18
    v_cmp_ne_u32 vcc, s101, v19
    v_cmp_ne_u32 s[16:17], s23, v26
    s_or_b64 s[62:63], vcc, s[16:17]
    v_lshrrev_b32 v26, 22, v20
    v_cmp_ne_u32 vcc, s101, v21
    v_cmp_ne_u32 s[16:17], s23, v26
    s_or_b64 s[64:65], vcc, s[16:17]
    v_lshrrev_b32 v26, 22, v22
    v_cmp_ne_u32 vcc, s101, v23
    v_cmp_ne_u32 s[16:17], s23, v26
    s_or_b64 s[66:67], vcc, s[16:17]
    s_or_b64 s[16:17], s[60:61], s[62:63]
    s_or_b64 vcc, s[64:65], s[66:67]
    s_or_b64 s[16:17], s[16:17], vcc
    s_cbranch_scc0 k_sp6x
    s_sleep 2
    s_sub_u32 s21, s21, 1
    s_cbranch_scc0 k_sp6
    s_endpgm
k_sp6x:
    ds_write_b32 v15, v16
    ds_write_b32 v15, v18 offset:256
    ds_write_b32 v15, v20 offset:512
    ds_write_b32 v15, v22 offset:768
k_join:
    v_lshrrev_b32 v1, 2, v0
    v_lshlrev_b32 v2, 2, v1
    v_add_u32 v2, 135168, v2
    v_mul_u32_u24 v1, 15360, v1
    s_waitcnt lgkmcnt(0)
    s_barrier
    ds_read_b32 v28, v2
    s_waitcnt lgkmcnt(0)
    v_and_b32 v27, 0x7ff, v28
    v_bfe_u32 v2, v28, 11, 11
    v_add_u32 v27, v27, v24
    v_sub_u32 v2, v2, v24
    v_mad_u32_u24 v1, v27, 12, v1
k_loadrec:
    s_mov_b32 s79, 32
    v_cmp_lt_i32 s[60:61], 0, v2
    v_cmp_lt_i32 s[62:63], 4, v2
    s_mov_b64 exec, s[60:61]
    s_cbranch_execz k_ldiss
    buffer_load_dwordx3 v[42:44], v1, s[44:47], 0 offen offset:0
    v_cmp_lt_i32 s[64:65], 8, v2
    s_mov_b64 exec, s[62:63]
    s_cbranch_execz k_ldiss
    buffer_load_dwordx3 v[46:48], v1, s[44:47], 0 offen offset:48
    v_cmp_lt_i32 s[66:67], 12, v2
    s_mov_b64 exec, s[64:65]
    s_cbranch_execz k_ldiss
    buffer_load_dwordx3 v[50:52], v1, s[44:47], 0 offen offset:96
    v_cmp_lt_i32 s[68:69], 16, v2
    s_mov_b64 exec, s[66:67]
    s_cbranch_execz k_ldiss
    buffer_load_dwordx3 v[54:56], v1, s[44:47], 0 offen offset:144
    v_cmp_lt_i32 s[70:71], 20, v2
    s_mov_b64 exec, s[68:69]
    s_cbranch_execz k_ldiss
    buffer_load_dwordx3 v[58:60], v1, s[44:47], 0 offen offset:192
    v_cmp_lt_i32 s[72:73], 24, v2
    s_mov_b64 exec, s[70:71]
    s_cbranch_execz k_ldiss
    buffer_load_dwordx3 v[62:64], v1, s[44:47], 0 offen offset:240
    v_cmp_lt_i32 s[74:75], 28, v2
    s_mov_b64 exec, s[72:73]
    s_cbranch_execz k_ldiss
    buffer_load_dwordx3 v[66:68], v1, s[44:47], 0 offen offset:288
    s_mov_b64 exec, s[74:75]
    s_cbranch_execz k_ldiss
    buffer_load_dwordx3 v[70:72], v1, s[44:47], 0 offen offset:336
k_ldiss:
    s_mov_b64 exec, -1
    s_cmp_eq_u32 s100, 0
    s_cbranch_scc1 k_later
    v_lshlrev_b32 v25, 1, v3
    v_add_u32 v25, 153088, v25
    v_lshrrev_b32 v74, 3, v0
    v_bfe_u32 v4, v0, 2, 1
    v_lshl_or_b32 v4, s5, 3, v4
    v_xor_b32 v4, v4, v74
    v_and_b32 v4, 15, v4
    v_lshlrev_b32 v74, 8, v74
    v_lshl_or_b32 v4, v4, 4, v74
    v_lshl_or_b32 v4, v24, 2, v4
    v_add_u32 v4, 114688, v4
    v_xor_b32 v5, 32, v4
    v_xor_b32 v6, 64, v4
    v_xor_b32 v7, 96, v4
    ds_read_u16 v14, v25
    ds_read_u16 v15, v25 offset:128
    ds_read_u16 v16, v25 offset:256
    ds_read_u16 v17, v25 offset:384
    s_cmp_ge_u32 s4, 10
    s_cbranch_scc1 k_noxr
    ds_read_b32 v4, v4
    ds_read_b32 v5, v5
    ds_read_b32 v6, v6
    ds_read_b32 v7, v7
k_noxr:
    v_and_b32 v78, 1, v3
    v_lshlrev_b32 v78, 4, v78
    v_mov_b32 v79, 0x3f80
    v_lshlrev_b32 v79, v78, v79
    v_and_b32 v78, 2, v3
    v_cmp_eq_u32 vcc, 0, v78
    v_mov_b64 v[74:75], 0
    v_mov_b64 v[76:77], 0
    v_cndmask_b32 v12, 0, v79, vcc
    v_cndmask_b32 v13, v79, v74, vcc
    s_mov_b32 s56, 0x21800000
    s_mov_b32 s57, 0x21800000
    s_mov_b32 s58, 0x22221111
    s_mov_b32 s59, 0x88884444
    s_mov_b32 s20, 0xbfb8aa3b
    v_lshlrev_b32 v78, 4, v0
    s_waitcnt lgkmcnt(0)
    ds_write_b128 v78, v[74:77] offset:40960
    ds_write_b128 v78, v[74:77] offset:57344
    s_cmp_ge_u32 s4, 8
    s_cbranch_scc1 k_noz
    v_add_u32 v78, 32768, v78
    ds_write_b128 v78, v[74:77] offset:40960
k_noz:
    v_lshlrev_b32 v14, 16, v14
    v_lshlrev_b32 v15, 16, v15
    v_lshlrev_b32 v16, 16, v16
    v_lshlrev_b32 v17, 16, v17
    v_mul_f32 v14, s20, v14
    v_mul_f32 v15, s20, v15
    v_mul_f32 v16, s20, v16
    v_mul_f32 v17, s20, v17
    v_cvt_pk_bf16_f32 v8, v14, v15
    v_cvt_pk_bf16_f32 v9, v16, v17
k_later:
    v_and_b32 v23, 15, v3
    v_lshlrev_b32 v23, 4, v23
    v_mov_b32 v25, v23
    v_lshrrev_b32 v122, 4, v3
    s_lshl_b32 s89, s4, 2
    v_add_u32 v21, s89, v122
    v_lshl_add_u32 v24, v21, 9, v23
    v_add_u32 v24, 40960, v24
    v_add_u32 v22, 1, v21
    v_bfe_u32 v121, v3, 2, 2
    v_mov_b32 v10, 32
    v_cndmask_b32 v11, 0, 64, s[58:59]
    v_mov_b64 v[34:35], 0
    v_mov_b64 v[36:37], 0
    v_mov_b64 v[38:39], 0
    v_mov_b64 v[40:41], 0
    s_mov_b64 s[84:85], 0
    s_mov_b64 s[86:87], 0
    v_mov_b32 v15, 161536
    v_mov_b32 v103, v23
    v_mov_b32 v105, v23
    v_mov_b32 v107, v23
    v_mov_b32 v109, v23
    v_mov_b32 v111, v23
    v_mov_b32 v113, v23
    v_mov_b32 v115, v23
    v_mov_b32 v117, v23
    s_mul_i32 s20, s78, 313
    s_mul_i32 s21, s4, 7
    s_add_u32 s20, s20, s21
    s_add_u32 s20, s20, 0
    v_lshrrev_b32 v118, 1, v3
    v_add_u32 v118, s20, v118
    v_and_b32 v119, 1, v3
    v_lshlrev_b32 v119, 7, v119
    v_lshlrev_b32 v90, 7, v3
    s_lshl_b32 s20, s5, 14
    s_add_u32 s22, s20, 8192
    s_waitcnt vmcnt(0)
    s_cmp_lg_u32 s4, 15
    s_cbranch_scc1 k_nofx
    buffer_load_dwordx2 v[92:93], v90, s[80:83], s20 offen sc1
    buffer_load_dwordx2 v[94:95], v90, s[80:83], s22 offen sc1
k_nofx:
k_rank:
    s_mov_b64 exec, s[60:61]
    s_cbranch_execz k_rankdone
    v_lshrrev_b32 v74, 14, v44
    v_add_u32 v74, v15, v74
    ds_add_rtn_u32 v45, v74, v123
    s_mov_b64 exec, s[62:63]
    s_cbranch_execz k_rankdone
    v_lshrrev_b32 v75, 14, v48
    v_add_u32 v75, v15, v75
    ds_add_rtn_u32 v49, v75, v123
    s_mov_b64 exec, s[64:65]
    s_cbranch_execz k_rankdone
    v_lshrrev_b32 v76, 14, v52
    v_add_u32 v76, v15, v76
    ds_add_rtn_u32 v53, v76, v123
    s_mov_b64 exec, s[66:67]
    s_cbranch_execz k_rankdone
    v_lshrrev_b32 v77, 14, v56
    v_add_u32 v77, v15, v77
    ds_add_rtn_u32 v57, v77, v123
    s_mov_b64 exec, s[68:69]
    s_cbranch_execz k_rankdone
    v_lshrrev_b32 v78, 14, v60
    v_add_u32 v78, v15, v78
    ds_add_rtn_u32 v61, v78, v123
    s_mov_b64 exec, s[70:71]
    s_cbranch_execz k_rankdone
    v_lshrrev_b32 v79, 14, v64
    v_add_u32 v79, v15, v79
    ds_add_rtn_u32 v65, v79, v123
    s_mov_b64 exec, s[72:73]
    s_cbranch_execz k_rankdone
    v_lshrrev_b32 v80, 14, v68
    v_add_u32 v80, v15, v80
    ds_add_rtn_u32 v69, v80, v123
    s_mov_b64 exec, s[74:75]
    s_cbranch_execz k_rankdone
    v_lshrrev_b32 v81, 14, v72
    v_add_u32 v81, v15, v81
    ds_add_rtn_u32 v73, v81, v123
    v_cmp_lt_i32 vcc, 32, v2
    s_and_b64 exec, exec, vcc
    s_cbranch_execz k_rankdone
    ds_write_b32 v15, v123 offset:1664
k_rankdone:
    s_mov_b64 exec, -1
    s_waitcnt lgkmcnt(0)
    s_barrier
    s_cmp_lg_u32 s4, 15
    s_cbranch_scc1 k_nofs
    s_lshl_b32 s20, s5, 14
    s_mov_b32 s21, 0x100000
    s_add_u32 s22, s20, 8192
    s_movk_i32 s23, 677
    s_branch k_sp9_c
k_sp9:
    s_mov_b64 exec, s[36:37]
    s_cbranch_execz k_sp9_a
    buffer_load_dwordx2 v[92:93], v90, s[80:83], s20 offen sc1
k_sp9_a:
    s_mov_b64 exec, s[38:39]
    s_cbranch_execz k_sp9_b
    buffer_load_dwordx2 v[94:95], v90, s[80:83], s22 offen sc1
k_sp9_b:
    s_mov_b64 exec, -1
k_sp9_c:
    s_waitcnt vmcnt(0)
    v_cmp_ne_u32 vcc, s101, v92
    v_cmp_ne_u32 s[16:17], s23, v93
    s_or_b64 s[36:37], vcc, s[16:17]
    v_cmp_ne_u32 vcc, s101, v94
    v_cmp_ne_u32 s[16:17], s23, v95
    s_or_b64 s[38:39], vcc, s[16:17]
    s_or_b64 s[16:17], s[36:37], s[38:39]
    s_cbranch_scc0 k_nofs
    s_sleep 2
    s_sub_u32 s21, s21, 1
    s_cbranch_scc0 k_sp9
    s_endpgm
k_nofs:
    s_cmp_lg_u32 s4, 0
    s_cbranch_scc1 k_noscan
    v_lshl_add_u32 v16, v3, 3, v15
    ds_read_b64 v[18:19], v16
    s_waitcnt lgkmcnt(0)
    v_add_u32 v18, 1, v18
    v_add_u32 v19, 1, v19
    v_and_b32 v18, -2, v18
    v_and_b32 v19, -2, v19
    v_add_u32 v26, v18, v19
    v_mov_b32 v27, v26
    s_nop 1
    v_add_u32_dpp v26, v26, v26 row_shr:1 row_mask:0xf bank_mask:0xf bound_ctrl:0
    s_nop 1
    v_add_u32_dpp v26, v26, v26 row_shr:2 row_mask:0xf bank_mask:0xf bound_ctrl:0
    s_nop 1
    v_add_u32_dpp v26, v26, v26 row_shr:4 row_mask:0xf bank_mask:0xf bound_ctrl:0
    s_nop 1
    v_add_u32_dpp v26, v26, v26 row_shr:8 row_mask:0xf bank_mask:0xf bound_ctrl:0
    s_nop 1
    v_add_u32_dpp v26, v26, v26 row_bcast:15 row_mask:0xa bank_mask:0xf
    s_nop 1
    v_add_u32_dpp v26, v26, v26 row_bcast:31 row_mask:0xc bank_mask:0xf
    v_sub_u32 v26, v26, v27
    v_add_u32 v27, v26, v18
    ds_write_b64 v16, v[26:27] offset:512
    s_waitcnt lgkmcnt(0)
k_noscan:
    s_barrier
    s_mov_b32 exec_lo, 0x3fff
    s_mov_b32 exec_hi, 0x0
    buffer_load_dword v120, v[118:119], s[48:51], 0 idxen offen
    s_mov_b64 exec, -1
    ds_read_b32 v16, v15 offset:912
    ds_read_b32 v17, v15 offset:1664
    s_mov_b64 exec, s[60:61]
    s_cbranch_execz k_st
    ds_read_b32 v82, v74 offset:512
    s_mov_b64 exec, s[62:63]
    s_cbranch_execz k_st
    ds_read_b32 v83, v75 offset:512
    s_mov_b64 exec, s[64:65]
    s_cbranch_execz k_st
    ds_read_b32 v84, v76 offset:512
    s_mov_b64 exec, s[66:67]
    s_cbranch_execz k_st
    ds_read_b32 v85, v77 offset:512
    s_mov_b64 exec, s[68:69]
    s_cbranch_execz k_st
    ds_read_b32 v86, v78 offset:512
    s_mov_b64 exec, s[70:71]
    s_cbranch_execz k_st
    ds_read_b32 v87, v79 offset:512
    s_mov_b64 exec, s[72:73]
    s_cbranch_execz k_st
    ds_read_b32 v88, v80 offset:512
    s_mov_b64 exec, s[74:75]
    s_cbranch_execz k_st
    ds_read_b32 v89, v81 offset:512
k_st:
    s_mov_b64 exec, -1
    v_lshl_add_u32 v18, v0, 2, v15
    s_cmp_ge_u32 s4, 2
    s_cbranch_scc1 k_nopad0
    ds_read_b32 v19, v18
    ds_read_b32 v20, v18 offset:512
k_nopad0:
    s_mov_b32 s20, 114688
    s_mov_b32 s21, 145920
    s_waitcnt lgkmcnt(0)
    v_readfirstlane_b32 s22, v16
    v_readfirstlane_b32 s88, v17
    s_cmp_gt_u32 s22, 3888
    s_cbranch_scc1 k_shrink
    s_cmp_ge_u32 s4, 2
    s_cbranch_scc1 k_nopad
    v_subrev_u32 v26, 80, v0
    v_cmp_gt_u32 vcc, 80, v0
    v_min_u32 v27, 79, v0
    v_lshlrev_b32 v27, 16, v27
    v_or_b32 v27, 10000, v27
    v_cndmask_b32 v28, v26, v19, vcc
    v_add_u32 v20, v20, v28
    v_and_b32 v19, 1, v19
    v_cmp_eq_u32 vcc, 1, v19
    v_cmp_gt_u32 s[76:77], 8, v26
    s_or_b64 exec, vcc, s[76:77]
    s_cbranch_execz k_nopad
    v_lshl_add_u32 v28, v20, 3, s20
    v_lshl_add_u32 v20, v20, 2, s21
    ds_write_b64 v28, v[34:35]
    ds_write_b32 v20, v27
k_nopad:
    s_mov_b64 exec, s[60:61]
    s_cbranch_execz k_scat
    v_add_u32 v82, v82, v45
    v_lshl_add_u32 v74, v82, 3, s20
    v_lshl_add_u32 v82, v82, 2, s21
    ds_write_b64 v74, v[42:43]
    ds_write_b32 v82, v44
    s_mov_b64 exec, s[62:63]
    s_cbranch_execz k_scat
    v_add_u32 v83, v83, v49
    v_lshl_add_u32 v75, v83, 3, s20
    v_lshl_add_u32 v83, v83, 2, s21
    ds_write_b64 v75, v[46:47]
    ds_write_b32 v83, v48
    s_mov_b64 exec, s[64:65]
    s_cbranch_execz k_scat
    v_add_u32 v84, v84, v53
    v_lshl_add_u32 v76, v84, 3, s20
    v_lshl_add_u32 v84, v84, 2, s21
    ds_write_b64 v76, v[50:51]
    ds_write_b32 v84, v52
    s_mov_b64 exec, s[66:67]
    s_cbranch_execz k_scat
    v_add_u32 v85, v85, v57
    v_lshl_add_u32 v77, v85, 3, s20
    v_lshl_add_u32 v85, v85, 2, s21
    ds_write_b64 v77, v[54:55]
    ds_write_b32 v85, v56
    s_mov_b64 exec, s[68:69]
    s_cbranch_execz k_scat
    v_add_u32 v86, v86, v61
    v_lshl_add_u32 v78, v86, 3, s20
    v_lshl_add_u32 v86, v86, 2, s21
    ds_write_b64 v78, v[58:59]
    ds_write_b32 v86, v60
    s_mov_b64 exec, s[70:71]
    s_cbranch_execz k_scat
    v_add_u32 v87, v87, v65
    v_lshl_add_u32 v79, v87, 3, s20
    v_lshl_add_u32 v87, v87, 2, s21
    ds_write_b64 v79, v[62:63]
    ds_write_b32 v87, v64
    s_mov_b64 exec, s[72:73]
    s_cbranch_execz k_scat
    v_add_u32 v88, v88, v69
    v_lshl_add_u32 v80, v88, 3, s20
    v_lshl_add_u32 v88, v88, 2, s21
    ds_write_b64 v80, v[66:67]
    ds_write_b32 v88, v68
    s_mov_b64 exec, s[74:75]
    s_cbranch_execz k_scat
    v_add_u32 v89, v89, v73
    v_lshl_add_u32 v81, v89, 3, s20
    v_lshl_add_u32 v89, v89, 2, s21
    ds_write_b64 v81, v[70:71]
    ds_write_b32 v89, v72
k_scat:
    s_mov_b64 exec, -1
    s_add_u32 s22, s22, 6
    s_lshr_b32 s22, s22, 3
    s_lshr_b32 s23, s22, 4
    s_mov_b32 s89, s23
    s_and_b32 s22, s22, 15
    s_mul_i32 s16, s23, s4
    s_min_u32 s17, s4, s22
    s_add_u32 s16, s16, s17
    s_cmp_lt_u32 s4, s22
    s_addc_u32 s23, s23, 0
    s_cmp_lt_u32 s89, 6
    s_cbranch_scc1 k_nosk
    s_and_b32 s17, s4, 12
    s_lshr_b32 s36, 0x679a, s17
    s_lshr_b32 s37, 0xaba8, s17
    s_and_b32 s36, s36, 15
    s_and_b32 s37, s37, 15
    s_sub_i32 s36, s36, 8
    s_sub_i32 s37, s37, 8
    s_and_b32 s17, s4, 3
    s_mul_i32 s17, s17, s36
    s_lshl_b32 s37, s37, 2
    s_add_i32 s16, s16, s17
    s_add_i32 s16, s16, s37
    s_add_i32 s23, s23, s36
k_nosk:
    s_lshl_b32 s16, s16, 5
    s_add_u32 s21, s21, s16
    s_lshl_b32 s16, s16, 1
    s_add_u32 s20, s20, s16
    v_mul_u32_u24 v16, s23, v122
    v_mul_u32_u24 v17, s23, v121
    v_mov_b32 v26, 163216
    v_lshl_add_u32 v14, v16, 3, s21
    v_lshl_add_u32 v15, v17, 4, s20
    v_mov_b32 v18, v24
    v_mov_b32 v21, v22
    v_mov_b32 v20, 163204
    v_cndmask_b32 v15, v26, v15, s[58:59]
    s_mov_b32 s76, 0x00010001
    s_mov_b32 s77, 0x00010001
    s_waitcnt lgkmcnt(0)
    s_barrier
    s_setprio 3
    s_sub_u32 s23, s23, 1
    s_cbranch_scc1 k_empty
    ds_read_u16 v102, v14
    ds_read_u16 v104, v14 offset:4
    ds_read_u16 v106, v14 offset:8
    ds_read_u16 v108, v14 offset:12
    s_and_b32 s16, s23, 3
    s_lshr_b32 s23, s23, 2
    s_cmp_eq_u32 s16, 2
    s_cbranch_scc1 k_pro1
    s_cmp_eq_u32 s16, 1
    s_cbranch_scc1 k_pro2
    s_cmp_eq_u32 s16, 0
    s_cbranch_scc1 k_pro3
k_pro0:
    s_waitcnt lgkmcnt(2)
    buffer_load_dwordx4 v[70:73], v[102:103], s[48:51], 0 idxen offen
    buffer_load_dwordx4 v[74:77], v[104:105], s[48:51], 0 idxen offen
    s_waitcnt lgkmcnt(0)
    buffer_load_dwordx4 v[78:81], v[106:107], s[48:51], 0 idxen offen
    buffer_load_dwordx4 v[82:85], v[108:109], s[48:51], 0 idxen offen
    ds_read_u16 v110, v14 offset:16
    ds_read_u16 v112, v14 offset:20
    ds_read_u16 v114, v14 offset:24
    ds_read_u16 v116, v14 offset:28
    ds_read_u16 v16, v14 offset:2
    ds_read_b128 v[26:29], v15
    ds_read_u16 v17, v14 offset:10
    ds_read_u16 v19, v14 offset:18
    ds_read_u16 v22, v14 offset:32
    ds_read_u16 v24, v14 offset:36
    s_waitcnt lgkmcnt(5)
    v_lshl_add_u32 v118, v16, 9, v23
    ds_read_b128 v[30:33], v118
    v_lshlrev_b32 v118, 3, v16
    v_add_u32 v118, 162560, v118
    s_mov_b64 exec, s[76:77]
    ds_add_u32 v118, v123
    ds_max_u32 v118, v21 offset:4
    ds_add_u32 v20, v123
    s_mov_b64 exec, -1
    s_waitcnt lgkmcnt(3)
    v_mfma_f32_16x16x16_bf16 v[42:45], v[26:27], v[8:9], v[30:33]
    v_cmp_ne_u32 s[84:85], v16, v17
    v_lshl_add_u32 v118, v17, 9, v23
    v_mfma_f32_16x16x16_bf16 v[46:49], v[28:29], v[8:9], v[30:33]
    ds_read_b128 v[26:29], v15 offset:16
    ds_read_b128 v[30:33], v118
    s_nop 2
    s_waitcnt vmcnt(2)
    v_mfma_f32_4x4x4_16b_bf16 v[42:45], v[12:13], v[70:71], v[42:45]
    v_mfma_f32_4x4x4_16b_bf16 v[46:49], v[12:13], v[74:75], v[46:49]
    buffer_load_dwordx4 v[86:89], v[110:111], s[48:51], 0 idxen offen
    buffer_load_dwordx4 v[90:93], v[112:113], s[48:51], 0 idxen offen
    buffer_load_dwordx4 v[94:97], v[114:115], s[48:51], 0 idxen offen
    buffer_load_dwordx4 v[98:101], v[116:117], s[48:51], 0 idxen offen
    s_waitcnt lgkmcnt(0)
    s_cmp_eq_u32 s23, 0
    s_cbranch_scc1 k_f0
    s_branch k_loop
k_pro1:
    s_waitcnt lgkmcnt(2)
    buffer_load_dwordx4 v[78:81], v[102:103], s[48:51], 0 idxen offen
    buffer_load_dwordx4 v[82:85], v[104:105], s[48:51], 0 idxen offen
    s_waitcnt lgkmcnt(0)
    buffer_load_dwordx4 v[86:89], v[106:107], s[48:51], 0 idxen offen
    buffer_load_dwordx4 v[90:93], v[108:109], s[48:51], 0 idxen offen
    ds_read_u16 v110, v14 offset:16
    ds_read_u16 v112, v14 offset:20
    ds_read_u16 v114, v14 offset:24
    ds_read_u16 v116, v14 offset:28
    ds_read_u16 v17, v14 offset:2
    ds_read_b128 v[26:29], v15
    ds_read_u16 v19, v14 offset:10
    ds_read_u16 v119, v14 offset:18
    ds_read_u16 v22, v14 offset:32
    ds_read_u16 v24, v14 offset:36
    s_waitcnt lgkmcnt(5)
    v_lshl_add_u32 v118, v17, 9, v23
    ds_read_b128 v[30:33], v118
    v_lshlrev_b32 v118, 3, v17
    v_add_u32 v118, 162560, v118
    s_mov_b64 exec, s[76:77]
    ds_add_u32 v118, v123
    ds_max_u32 v118, v21 offset:4
    ds_add_u32 v20, v123
    s_mov_b64 exec, -1
    s_waitcnt lgkmcnt(3)
    v_mfma_f32_16x16x16_bf16 v[102:105], v[26:27], v[8:9], v[30:33]
    v_cmp_ne_u32 s[86:87], v17, v19
    v_lshl_add_u32 v118, v19, 9, v23
    v_mfma_f32_16x16x16_bf16 v[106:109], v[28:29], v[8:9], v[30:33]
    ds_read_b128 v[26:29], v15 offset:16
    ds_read_b128 v[30:33], v118
    v_subrev_u32 v14, 8, v14
    v_cndmask_b32 v118, 0, 16, s[58:59]
    v_sub_u32 v15, v15, v118
    s_waitcnt vmcnt(2)
    v_mfma_f32_4x4x4_16b_bf16 v[102:105], v[12:13], v[78:79], v[102:105]
    v_mfma_f32_4x4x4_16b_bf16 v[106:109], v[12:13], v[82:83], v[106:109]
    buffer_load_dwordx4 v[94:97], v[110:111], s[48:51], 0 idxen offen
    buffer_load_dwordx4 v[98:101], v[112:113], s[48:51], 0 idxen offen
    buffer_load_dwordx4 v[70:73], v[114:115], s[48:51], 0 idxen offen
    buffer_load_dwordx4 v[74:77], v[116:117], s[48:51], 0 idxen offen
    s_waitcnt lgkmcnt(0)
    s_cmp_eq_u32 s23, 0
    s_cbranch_scc1 k_f1
    s_branch k_m1
k_pro2:
    s_waitcnt lgkmcnt(2)
    buffer_load_dwordx4 v[86:89], v[102:103], s[48:51], 0 idxen offen
    buffer_load_dwordx4 v[90:93], v[104:105], s[48:51], 0 idxen offen
    s_waitcnt lgkmcnt(0)
    buffer_load_dwordx4 v[94:97], v[106:107], s[48:51], 0 idxen offen
    buffer_load_dwordx4 v[98:101], v[108:109], s[48:51], 0 idxen offen
    ds_read_u16 v110, v14 offset:16
    ds_read_u16 v112, v14 offset:20
    ds_read_u16 v114, v14 offset:24
    ds_read_u16 v116, v14 offset:28
    ds_read_u16 v19, v14 offset:2
    ds_read_b128 v[26:29], v15
    ds_read_u16 v119, v14 offset:10
    ds_read_u16 v16, v14 offset:18
    ds_read_u16 v22, v14 offset:32
    ds_read_u16 v24, v14 offset:36
    s_waitcnt lgkmcnt(5)
    v_lshl_add_u32 v118, v19, 9, v23
    ds_read_b128 v[30:33], v118
    v_lshlrev_b32 v118, 3, v19
    v_add_u32 v118, 162560, v118
    s_mov_b64 exec, s[76:77]
    ds_add_u32 v118, v123
    ds_max_u32 v118, v21 offset:4
    ds_add_u32 v20, v123
    s_mov_b64 exec, -1
    s_waitcnt lgkmcnt(3)
    v_mfma_f32_16x16x16_bf16 v[42:45], v[26:27], v[8:9], v[30:33]
    v_cmp_ne_u32 s[84:85], v19, v119
    v_lshl_add_u32 v118, v119, 9, v23
    v_mfma_f32_16x16x16_bf16 v[46:49], v[28:29], v[8:9], v[30:33]
    ds_read_b128 v[26:29], v15 offset:16
    ds_read_b128 v[30:33], v118
    v_subrev_u32 v14, 16, v14
    v_cndmask_b32 v118, 0, 32, s[58:59]
    v_sub_u32 v15, v15, v118
    s_waitcnt vmcnt(2)
    v_mfma_f32_4x4x4_16b_bf16 v[42:45], v[12:13], v[86:87], v[42:45]
    v_mfma_f32_4x4x4_16b_bf16 v[46:49], v[12:13], v[90:91], v[46:49]
    buffer_load_dwordx4 v[70:73], v[110:111], s[48:51], 0 idxen offen
    buffer_load_dwordx4 v[74:77], v[112:113], s[48:51], 0 idxen offen
    buffer_load_dwordx4 v[78:81], v[114:115], s[48:51], 0 idxen offen
    buffer_load_dwordx4 v[82:85], v[116:117], s[48:51], 0 idxen offen
    s_waitcnt lgkmcnt(0)
    s_cmp_eq_u32 s23, 0
    s_cbranch_scc1 k_f2
    s_branch k_m2
k_pro3:
    s_waitcnt lgkmcnt(2)
    buffer_load_dwordx4 v[94:97], v[102:103], s[48:51], 0 idxen offen
    buffer_load_dwordx4 v[98:101], v[104:105], s[48:51], 0 idxen offen
    s_waitcnt lgkmcnt(0)
    buffer_load_dwordx4 v[70:73], v[106:107], s[48:51], 0 idxen offen
    buffer_load_dwordx4 v[74:77], v[108:109], s[48:51], 0 idxen offen
    ds_read_u16 v110, v14 offset:16
    ds_read_u16 v112, v14 offset:20
    ds_read_u16 v114, v14 offset:24
    ds_read_u16 v116, v14 offset:28
    ds_read_u16 v119, v14 offset:2
    ds_read_b128 v[26:29], v15
    ds_read_u16 v16, v14 offset:10
    ds_read_u16 v17, v14 offset:18
    ds_read_u16 v22, v14 offset:32
    ds_read_u16 v24, v14 offset:36
    s_waitcnt lgkmcnt(5)
    v_lshl_add_u32 v118, v119, 9, v23
    ds_read_b128 v[30:33], v118
    v_lshlrev_b32 v118, 3, v119
    v_add_u32 v118, 162560, v118
    s_mov_b64 exec, s[76:77]
    ds_add_u32 v118, v123
    ds_max_u32 v118, v21 offset:4
    ds_add_u32 v20, v123
    s_mov_b64 exec, -1
    s_waitcnt lgkmcnt(3)
    v_mfma_f32_16x16x16_bf16 v[102:105], v[26:27], v[8:9], v[30:33]
    v_cmp_ne_u32 s[86:87], v119, v16
    v_lshl_add_u32 v118, v16, 9, v23
    v_mfma_f32_16x16x16_bf16 v[106:109], v[28:29], v[8:9], v[30:33]
    ds_read_b128 v[26:29], v15 offset:16
    ds_read_b128 v[30:33], v118
    v_subrev_u32 v14, 24, v14
    v_cndmask_b32 v118, 0, 48, s[58:59]
    v_sub_u32 v15, v15, v118
    s_waitcnt vmcnt(2)
    v_mfma_f32_4x4x4_16b_bf16 v[102:105], v[12:13], v[94:95], v[102:105]
    v_mfma_f32_4x4x4_16b_bf16 v[106:109], v[12:13], v[98:99], v[106:109]
    buffer_load_dwordx4 v[78:81], v[110:111], s[48:51], 0 idxen offen
    buffer_load_dwordx4 v[82:85], v[112:113], s[48:51], 0 idxen offen
    buffer_load_dwordx4 v[86:89], v[114:115], s[48:51], 0 idxen offen
    buffer_load_dwordx4 v[90:93], v[116:117], s[48:51], 0 idxen offen
    s_waitcnt lgkmcnt(0)
    s_cmp_eq_u32 s23, 0
    s_cbranch_scc1 k_f3
    s_branch k_m3
k_evbm0:
    s_mov_b64 exec, s[84:85]
    ds_write_b128 v18, v[34:37] offset:40960
    ds_write_b128 v18, v[38:41] offset:41216
    v_lshl_add_u32 v18, v17, 9, v23
    s_mov_b64 s[84:85], 0
    ds_read_b128 v[34:37], v18 offset:40960
    ds_read_b128 v[38:41], v18 offset:41216
    s_mov_b64 exec, -1
    s_branch k_bkbm0
k_evbm1:
    s_mov_b64 exec, s[86:87]
    ds_write_b128 v18, v[34:37] offset:40960
    ds_write_b128 v18, v[38:41] offset:41216
    v_lshl_add_u32 v18, v19, 9, v23
    s_mov_b64 s[86:87], 0
    ds_read_b128 v[34:37], v18 offset:40960
    ds_read_b128 v[38:41], v18 offset:41216
    s_mov_b64 exec, -1
    s_branch k_bkbm1
k_evbm2:
    s_mov_b64 exec, s[84:85]
    ds_write_b128 v18, v[34:37] offset:40960
    ds_write_b128 v18, v[38:41] offset:41216
    v_lshl_add_u32 v18, v119, 9, v23
    s_mov_b64 s[84:85], 0
    ds_read_b128 v[34:37], v18 offset:40960
    ds_read_b128 v[38:41], v18 offset:41216
    s_mov_b64 exec, -1
    s_branch k_bkbm2
k_evbm3:
    s_mov_b64 exec, s[86:87]
    ds_write_b128 v18, v[34:37] offset:40960
    ds_write_b128 v18, v[38:41] offset:41216
    v_lshl_add_u32 v18, v16, 9, v23
    s_mov_b64 s[86:87], 0
    ds_read_b128 v[34:37], v18 offset:40960
    ds_read_b128 v[38:41], v18 offset:41216
    s_mov_b64 exec, -1
    s_branch k_bkbm3
k_evam0:
    s_mov_b64 exec, vcc
    v_lshl_add_u32 v118, v19, 9, v23
    s_mov_b64 s[86:87], vcc
    ds_read_b128 v[30:33], v118
    s_mov_b64 exec, -1
    s_branch k_bkam0
k_evam1:
    s_mov_b64 exec, vcc
    v_lshl_add_u32 v118, v119, 9, v23
    s_mov_b64 s[84:85], vcc
    ds_read_b128 v[30:33], v118
    s_mov_b64 exec, -1
    s_branch k_bkam1
k_evam2:
    s_mov_b64 exec, vcc
    v_lshl_add_u32 v118, v16, 9, v23
    s_mov_b64 s[86:87], vcc
    ds_read_b128 v[30:33], v118
    s_mov_b64 exec, -1
    s_branch k_bkam2
k_evam3:
    s_mov_b64 exec, vcc
    v_lshl_add_u32 v118, v17, 9, v23
    s_mov_b64 s[84:85], vcc
    ds_read_b128 v[30:33], v118
    s_mov_b64 exec, -1
    s_branch k_bkam3
k_setp:
    s_setprio 2
    s_cmp_eq_u32 s23, 2
    s_cbranch_scc1 k_m0
    s_setprio 1
    s_branch k_m0
k_loop:
    s_cmp_lt_u32 s23, 3
    s_cbranch_scc1 k_setp
k_m0:
    v_mfma_f32_4x4x4_16b_bf16 v[50:53], v[12:13], v[72:73], 0
    v_exp_f32_e64 v42, v42 clamp
    v_mfma_f32_4x4x4_16b_bf16 v[54:57], v[12:13], v[76:77], 0
    v_exp_f32_e64 v43, v43 clamp
    v_mfma_f32_16x16x16_bf16 v[102:105], v[26:27], v[8:9], v[30:33]
    v_exp_f32_e64 v44, v44 clamp
    buffer_load_dwordx4 v[70:73], v[22:23], s[48:51], 0 idxen offen
    v_exp_f32_e64 v45, v45 clamp
    buffer_load_dwordx4 v[74:77], v[24:25], s[48:51], 0 idxen offen
    v_exp_f32_e64 v46, v46 clamp
    v_mfma_f32_16x16x16_bf16 v[106:109], v[28:29], v[8:9], v[30:33]
    v_exp_f32_e64 v47, v47 clamp
    ds_read_b128 v[26:29], v15 offset:32
    ds_read_u16 v22, v14 offset:40
    v_exp_f32_e64 v48, v48 clamp
    ds_read_u16 v24, v14 offset:44
    ds_read_u16 v119, v14 offset:26
    v_cmp_ne_u32 vcc, v17, v19
    v_exp_f32_e64 v49, v49 clamp
    s_cbranch_vccnz k_evam0
k_bkam0:
    v_pk_add_f32 v[42:43], v[42:43], s[56:57]
    v_pk_add_f32 v[46:47], v[46:47], s[56:57]
    v_pk_add_f32 v[44:45], v[44:45], s[56:57]
    v_pk_add_f32 v[48:49], v[48:49], s[56:57]
    v_pk_mul_f32 v[58:59], v[42:43], v[46:47]
    v_pk_mul_f32 v[60:61], v[44:45], v[48:49]
    v_pk_mul_f32 v[66:67], v[46:47], v[50:51]
    s_waitcnt vmcnt(6) lgkmcnt(4)
    v_mfma_f32_4x4x4_16b_bf16 v[102:105], v[12:13], v[78:79], v[102:105]
    v_rcp_f32 v58, v58
    v_mfma_f32_4x4x4_16b_bf16 v[106:109], v[12:13], v[82:83], v[106:109]
    v_rcp_f32 v59, v59
    v_rcp_f32 v60, v60
    v_rcp_f32 v61, v61
    v_pk_mul_f32 v[68:69], v[48:49], v[52:53]
    v_pk_add_f32 v[62:63], v[42:43], v[46:47]
    v_pk_add_f32 v[64:65], v[44:45], v[48:49]
    v_pk_fma_f32 v[66:67], v[42:43], v[54:55], v[66:67]
    v_pk_fma_f32 v[68:69], v[44:45], v[56:57], v[68:69]
    v_pk_fma_f32 v[34:35], v[62:63], v[58:59], v[34:35]
    v_pk_fma_f32 v[36:37], v[64:65], v[60:61], v[36:37]
    v_pk_fma_f32 v[38:39], v[66:67], v[58:59], v[38:39]
    v_pk_fma_f32 v[40:41], v[68:69], v[60:61], v[40:41]
    s_waitcnt lgkmcnt(0)
    s_cmp_lg_u64 s[84:85], 0
    s_cbranch_scc1 k_evbm0
k_bkbm0:
k_m1:
    v_mfma_f32_4x4x4_16b_bf16 v[50:53], v[12:13], v[80:81], 0
    v_exp_f32_e64 v102, v102 clamp
    v_mfma_f32_4x4x4_16b_bf16 v[54:57], v[12:13], v[84:85], 0
    v_exp_f32_e64 v103, v103 clamp
    v_mfma_f32_16x16x16_bf16 v[42:45], v[26:27], v[8:9], v[30:33]
    v_exp_f32_e64 v104, v104 clamp
    buffer_load_dwordx4 v[78:81], v[22:23], s[48:51], 0 idxen offen
    v_exp_f32_e64 v105, v105 clamp
    buffer_load_dwordx4 v[82:85], v[24:25], s[48:51], 0 idxen offen
    v_exp_f32_e64 v106, v106 clamp
    v_mfma_f32_16x16x16_bf16 v[46:49], v[28:29], v[8:9], v[30:33]
    v_exp_f32_e64 v107, v107 clamp
    ds_read_b128 v[26:29], v15 offset:48
    ds_read_u16 v22, v14 offset:48
    v_exp_f32_e64 v108, v108 clamp
    ds_read_u16 v24, v14 offset:52
    ds_read_u16 v16, v14 offset:34
    v_cmp_ne_u32 vcc, v19, v119
    v_exp_f32_e64 v109, v109 clamp
    s_cbranch_vccnz k_evam1
k_bkam1:
    v_pk_add_f32 v[102:103], v[102:103], s[56:57]
    v_pk_add_f32 v[106:107], v[106:107], s[56:57]
    v_pk_add_f32 v[104:105], v[104:105], s[56:57]
    v_pk_add_f32 v[108:109], v[108:109], s[56:57]
    v_pk_mul_f32 v[58:59], v[102:103], v[106:107]
    v_pk_mul_f32 v[60:61], v[104:105], v[108:109]
    v_pk_mul_f32 v[66:67], v[106:107], v[50:51]
    s_waitcnt vmcnt(6) lgkmcnt(4)
    v_mfma_f32_4x4x4_16b_bf16 v[42:45], v[12:13], v[86:87], v[42:45]
    v_rcp_f32 v58, v58
    v_mfma_f32_4x4x4_16b_bf16 v[46:49], v[12:13], v[90:91], v[46:49]
    v_rcp_f32 v59, v59
    v_rcp_f32 v60, v60
    v_rcp_f32 v61, v61
    v_pk_mul_f32 v[68:69], v[108:109], v[52:53]
    v_pk_add_f32 v[62:63], v[102:103], v[106:107]
    v_pk_add_f32 v[64:65], v[104:105], v[108:109]
    v_pk_fma_f32 v[66:67], v[102:103], v[54:55], v[66:67]
    v_pk_fma_f32 v[68:69], v[104:105], v[56:57], v[68:69]
    v_pk_fma_f32 v[34:35], v[62:63], v[58:59], v[34:35]
    v_pk_fma_f32 v[36:37], v[64:65], v[60:61], v[36:37]
    v_pk_fma_f32 v[38:39], v[66:67], v[58:59], v[38:39]
    v_pk_fma_f32 v[40:41], v[68:69], v[60:61], v[40:41]
    s_waitcnt lgkmcnt(0)
    s_cmp_lg_u64 s[86:87], 0
    s_cbranch_scc1 k_evbm1
k_bkbm1:
k_m2:
    v_mfma_f32_4x4x4_16b_bf16 v[50:53], v[12:13], v[88:89], 0
    v_exp_f32_e64 v42, v42 clamp
    v_mfma_f32_4x4x4_16b_bf16 v[54:57], v[12:13], v[92:93], 0
    v_exp_f32_e64 v43, v43 clamp
    v_mfma_f32_16x16x16_bf16 v[102:105], v[26:27], v[8:9], v[30:33]
    v_exp_f32_e64 v44, v44 clamp
    buffer_load_dwordx4 v[86:89], v[22:23], s[48:51], 0 idxen offen
    v_exp_f32_e64 v45, v45 clamp
    buffer_load_dwordx4 v[90:93], v[24:25], s[48:51], 0 idxen offen
    v_exp_f32_e64 v46, v46 clamp
    v_mfma_f32_16x16x16_bf16 v[106:109], v[28:29], v[8:9], v[30:33]
    v_exp_f32_e64 v47, v47 clamp
    ds_read_b128 v[26:29], v15 offset:64
    ds_read_u16 v22, v14 offset:56
    v_exp_f32_e64 v48, v48 clamp
    ds_read_u16 v24, v14 offset:60
    ds_read_u16 v17, v14 offset:42
    v_cmp_ne_u32 vcc, v119, v16
    v_exp_f32_e64 v49, v49 clamp
    s_cbranch_vccnz k_evam2
k_bkam2:
    v_pk_add_f32 v[42:43], v[42:43], s[56:57]
    v_pk_add_f32 v[46:47], v[46:47], s[56:57]
    v_pk_add_f32 v[44:45], v[44:45], s[56:57]
    v_pk_add_f32 v[48:49], v[48:49], s[56:57]
    v_pk_mul_f32 v[58:59], v[42:43], v[46:47]
    v_pk_mul_f32 v[60:61], v[44:45], v[48:49]
    v_pk_mul_f32 v[66:67], v[46:47], v[50:51]
    s_waitcnt vmcnt(6) lgkmcnt(4)
    v_mfma_f32_4x4x4_16b_bf16 v[102:105], v[12:13], v[94:95], v[102:105]
    v_rcp_f32 v58, v58
    v_mfma_f32_4x4x4_16b_bf16 v[106:109], v[12:13], v[98:99], v[106:109]
    v_rcp_f32 v59, v59
    v_rcp_f32 v60, v60
    v_rcp_f32 v61, v61
    v_pk_mul_f32 v[68:69], v[48:49], v[52:53]
    v_pk_add_f32 v[62:63], v[42:43], v[46:47]
    v_pk_add_f32 v[64:65], v[44:45], v[48:49]
    v_pk_fma_f32 v[66:67], v[42:43], v[54:55], v[66:67]
    v_pk_fma_f32 v[68:69], v[44:45], v[56:57], v[68:69]
    v_pk_fma_f32 v[34:35], v[62:63], v[58:59], v[34:35]
    v_pk_fma_f32 v[36:37], v[64:65], v[60:61], v[36:37]
    v_pk_fma_f32 v[38:39], v[66:67], v[58:59], v[38:39]
    v_pk_fma_f32 v[40:41], v[68:69], v[60:61], v[40:41]
    s_waitcnt lgkmcnt(0)
    s_cmp_lg_u64 s[84:85], 0
    s_cbranch_scc1 k_evbm2
k_bkbm2:
k_m3:
    v_mfma_f32_4x4x4_16b_bf16 v[50:53], v[12:13], v[96:97], 0
    v_exp_f32_e64 v102, v102 clamp
    v_mfma_f32_4x4x4_16b_bf16 v[54:57], v[12:13], v[100:101], 0
    v_exp_f32_e64 v103, v103 clamp
    v_mfma_f32_16x16x16_bf16 v[42:45], v[26:27], v[8:9], v[30:33]
    v_exp_f32_e64 v104, v104 clamp
    buffer_load_dwordx4 v[94:97], v[22:23], s[48:51], 0 idxen offen
    v_exp_f32_e64 v105, v105 clamp
    buffer_load_dwordx4 v[98:101], v[24:25], s[48:51], 0 idxen offen
    v_exp_f32_e64 v106, v106 clamp
    v_mfma_f32_16x16x16_bf16 v[46:49], v[28:29], v[8:9], v[30:33]
    v_exp_f32_e64 v107, v107 clamp
    ds_read_b128 v[26:29], v15 offset:80
    ds_read_u16 v22, v14 offset:64
    v_exp_f32_e64 v108, v108 clamp
    ds_read_u16 v24, v14 offset:68
    ds_read_u16 v19, v14 offset:50
    v_cmp_ne_u32 vcc, v16, v17
    v_exp_f32_e64 v109, v109 clamp
    s_cbranch_vccnz k_evam3
k_bkam3:
    v_pk_add_f32 v[102:103], v[102:103], s[56:57]
    v_pk_add_f32 v[106:107], v[106:107], s[56:57]
    v_pk_add_f32 v[104:105], v[104:105], s[56:57]
    v_pk_add_f32 v[108:109], v[108:109], s[56:57]
    v_pk_mul_f32 v[58:59], v[102:103], v[106:107]
    v_pk_mul_f32 v[60:61], v[104:105], v[108:109]
    v_pk_mul_f32 v[66:67], v[106:107], v[50:51]
    s_waitcnt vmcnt(6) lgkmcnt(4)
    v_mfma_f32_4x4x4_16b_bf16 v[42:45], v[12:13], v[70:71], v[42:45]
    v_rcp_f32 v58, v58
    v_mfma_f32_4x4x4_16b_bf16 v[46:49], v[12:13], v[74:75], v[46:49]
    v_rcp_f32 v59, v59
    v_rcp_f32 v60, v60
    v_rcp_f32 v61, v61
    v_pk_mul_f32 v[68:69], v[108:109], v[52:53]
    v_pk_add_f32 v[62:63], v[102:103], v[106:107]
    v_pk_add_f32 v[64:65], v[104:105], v[108:109]
    v_pk_fma_f32 v[66:67], v[102:103], v[54:55], v[66:67]
    v_pk_fma_f32 v[68:69], v[104:105], v[56:57], v[68:69]
    v_lshl_add_u64 v[14:15], v[14:15], 0, v[10:11]
    v_pk_fma_f32 v[34:35], v[62:63], v[58:59], v[34:35]
    v_pk_fma_f32 v[36:37], v[64:65], v[60:61], v[36:37]
    v_pk_fma_f32 v[38:39], v[66:67], v[58:59], v[38:39]
    v_pk_fma_f32 v[40:41], v[68:69], v[60:61], v[40:41]
    s_waitcnt lgkmcnt(0)
    s_cmp_lg_u64 s[86:87], 0
    s_cbranch_scc1 k_evbm3
k_bkbm3:
    s_sub_u32 s23, s23, 1
    s_cmp_lg_u32 s23, 0
    s_cbranch_scc1 k_loop
    s_setprio 0
k_f0:
    v_mfma_f32_4x4x4_16b_bf16 v[50:53], v[12:13], v[72:73], 0
    v_exp_f32_e64 v42, v42 clamp
    v_mfma_f32_4x4x4_16b_bf16 v[54:57], v[12:13], v[76:77], 0
    v_exp_f32_e64 v43, v43 clamp
    v_mfma_f32_16x16x16_bf16 v[102:105], v[26:27], v[8:9], v[30:33]
    v_exp_f32_e64 v44, v44 clamp
    v_exp_f32_e64 v45, v45 clamp
    v_exp_f32_e64 v46, v46 clamp
    v_mfma_f32_16x16x16_bf16 v[106:109], v[28:29], v[8:9], v[30:33]
    v_exp_f32_e64 v47, v47 clamp
    ds_read_b128 v[26:29], v15 offset:32
    v_exp_f32_e64 v48, v48 clamp
    ds_read_u16 v119, v14 offset:26
    v_cmp_ne_u32 vcc, v17, v19
    v_exp_f32_e64 v49, v49 clamp
    s_cbranch_vccnz k_evaf0
k_bkaf0:
    v_pk_add_f32 v[42:43], v[42:43], s[56:57]
    v_pk_add_f32 v[46:47], v[46:47], s[56:57]
    v_pk_add_f32 v[44:45], v[44:45], s[56:57]
    v_pk_add_f32 v[48:49], v[48:49], s[56:57]
    v_pk_mul_f32 v[58:59], v[42:43], v[46:47]
    v_pk_mul_f32 v[60:61], v[44:45], v[48:49]
    v_pk_mul_f32 v[66:67], v[46:47], v[50:51]
    s_waitcnt vmcnt(4) lgkmcnt(2)
    v_mfma_f32_4x4x4_16b_bf16 v[102:105], v[12:13], v[78:79], v[102:105]
    v_rcp_f32 v58, v58
    v_mfma_f32_4x4x4_16b_bf16 v[106:109], v[12:13], v[82:83], v[106:109]
    v_rcp_f32 v59, v59
    v_rcp_f32 v60, v60
    v_rcp_f32 v61, v61
    v_pk_mul_f32 v[68:69], v[48:49], v[52:53]
    v_pk_add_f32 v[62:63], v[42:43], v[46:47]
    v_pk_add_f32 v[64:65], v[44:45], v[48:49]
    v_pk_fma_f32 v[66:67], v[42:43], v[54:55], v[66:67]
    v_pk_fma_f32 v[68:69], v[44:45], v[56:57], v[68:69]
    v_pk_fma_f32 v[34:35], v[62:63], v[58:59], v[34:35]
    v_pk_fma_f32 v[36:37], v[64:65], v[60:61], v[36:37]
    v_pk_fma_f32 v[38:39], v[66:67], v[58:59], v[38:39]
    v_pk_fma_f32 v[40:41], v[68:69], v[60:61], v[40:41]
    s_waitcnt lgkmcnt(0)
    s_cmp_lg_u64 s[84:85], 0
    s_cbranch_scc1 k_evbf0
k_bkbf0:
k_f1:
    v_mfma_f32_4x4x4_16b_bf16 v[50:53], v[12:13], v[80:81], 0
    v_exp_f32_e64 v102, v102 clamp
    v_mfma_f32_4x4x4_16b_bf16 v[54:57], v[12:13], v[84:85], 0
    v_exp_f32_e64 v103, v103 clamp
    v_mfma_f32_16x16x16_bf16 v[42:45], v[26:27], v[8:9], v[30:33]
    v_exp_f32_e64 v104, v104 clamp
    v_exp_f32_e64 v105, v105 clamp
    v_exp_f32_e64 v106, v106 clamp
    v_mfma_f32_16x16x16_bf16 v[46:49], v[28:29], v[8:9], v[30:33]
    v_exp_f32_e64 v107, v107 clamp
    ds_read_b128 v[26:29], v15 offset:48
    v_exp_f32_e64 v108, v108 clamp
    v_cmp_ne_u32 vcc, v19, v119
    v_exp_f32_e64 v109, v109 clamp
    s_cbranch_vccnz k_evaf1
k_bkaf1:
    v_pk_add_f32 v[102:103], v[102:103], s[56:57]
    v_pk_add_f32 v[106:107], v[106:107], s[56:57]
    v_pk_add_f32 v[104:105], v[104:105], s[56:57]
    v_pk_add_f32 v[108:109], v[108:109], s[56:57]
    v_pk_mul_f32 v[58:59], v[102:103], v[106:107]
    v_pk_mul_f32 v[60:61], v[104:105], v[108:109]
    v_pk_mul_f32 v[66:67], v[106:107], v[50:51]
    s_waitcnt vmcnt(2) lgkmcnt(1)
    v_mfma_f32_4x4x4_16b_bf16 v[42:45], v[12:13], v[86:87], v[42:45]
    v_rcp_f32 v58, v58
    v_mfma_f32_4x4x4_16b_bf16 v[46:49], v[12:13], v[90:91], v[46:49]
    v_rcp_f32 v59, v59
    v_rcp_f32 v60, v60
    v_rcp_f32 v61, v61
    v_pk_mul_f32 v[68:69], v[108:109], v[52:53]
    v_pk_add_f32 v[62:63], v[102:103], v[106:107]
    v_pk_add_f32 v[64:65], v[104:105], v[108:109]
    v_pk_fma_f32 v[66:67], v[102:103], v[54:55], v[66:67]
    v_pk_fma_f32 v[68:69], v[104:105], v[56:57], v[68:69]
    v_pk_fma_f32 v[34:35], v[62:63], v[58:59], v[34:35]
    v_pk_fma_f32 v[36:37], v[64:65], v[60:61], v[36:37]
    v_pk_fma_f32 v[38:39], v[66:67], v[58:59], v[38:39]
    v_pk_fma_f32 v[40:41], v[68:69], v[60:61], v[40:41]
    s_waitcnt lgkmcnt(0)
    s_cmp_lg_u64 s[86:87], 0
    s_cbranch_scc1 k_evbf1
k_bkbf1:
k_f2:
    v_mfma_f32_4x4x4_16b_bf16 v[50:53], v[12:13], v[88:89], 0
    v_exp_f32_e64 v42, v42 clamp
    v_mfma_f32_4x4x4_16b_bf16 v[54:57], v[12:13], v[92:93], 0
    v_exp_f32_e64 v43, v43 clamp
    v_mfma_f32_16x16x16_bf16 v[102:105], v[26:27], v[8:9], v[30:33]
    v_exp_f32_e64 v44, v44 clamp
    v_exp_f32_e64 v45, v45 clamp
    v_exp_f32_e64 v46, v46 clamp
    v_mfma_f32_16x16x16_bf16 v[106:109], v[28:29], v[8:9], v[30:33]
    v_exp_f32_e64 v47, v47 clamp
    v_exp_f32_e64 v48, v48 clamp
    v_exp_f32_e64 v49, v49 clamp
k_bkaf2:
    v_pk_add_f32 v[42:43], v[42:43], s[56:57]
    v_pk_add_f32 v[46:47], v[46:47], s[56:57]
    v_pk_add_f32 v[44:45], v[44:45], s[56:57]
    v_pk_add_f32 v[48:49], v[48:49], s[56:57]
    v_pk_mul_f32 v[58:59], v[42:43], v[46:47]
    v_pk_mul_f32 v[60:61], v[44:45], v[48:49]
    v_pk_mul_f32 v[66:67], v[46:47], v[50:51]
    s_waitcnt vmcnt(0) lgkmcnt(0)
    v_mfma_f32_4x4x4_16b_bf16 v[102:105], v[12:13], v[94:95], v[102:105]
    v_rcp_f32 v58, v58
    v_mfma_f32_4x4x4_16b_bf16 v[106:109], v[12:13], v[98:99], v[106:109]
    v_rcp_f32 v59, v59
    v_rcp_f32 v60, v60
    v_rcp_f32 v61, v61
    v_pk_mul_f32 v[68:69], v[48:49], v[52:53]
    v_pk_add_f32 v[62:63], v[42:43], v[46:47]
    v_pk_add_f32 v[64:65], v[44:45], v[48:49]
    v_pk_fma_f32 v[66:67], v[42:43], v[54:55], v[66:67]
    v_pk_fma_f32 v[68:69], v[44:45], v[56:57], v[68:69]
    v_pk_fma_f32 v[34:35], v[62:63], v[58:59], v[34:35]
    v_pk_fma_f32 v[36:37], v[64:65], v[60:61], v[36:37]
    v_pk_fma_f32 v[38:39], v[66:67], v[58:59], v[38:39]
    v_pk_fma_f32 v[40:41], v[68:69], v[60:61], v[40:41]
    s_waitcnt lgkmcnt(0)
    s_cmp_lg_u64 s[84:85], 0
    s_cbranch_scc1 k_evbf2
k_bkbf2:
k_f3:
    v_mfma_f32_4x4x4_16b_bf16 v[50:53], v[12:13], v[96:97], 0
    v_exp_f32_e64 v102, v102 clamp
    v_mfma_f32_4x4x4_16b_bf16 v[54:57], v[12:13], v[100:101], 0
    v_exp_f32_e64 v103, v103 clamp
    v_exp_f32_e64 v104, v104 clamp
    v_exp_f32_e64 v105, v105 clamp
    v_exp_f32_e64 v106, v106 clamp
    v_exp_f32_e64 v107, v107 clamp
    v_exp_f32_e64 v108, v108 clamp
    v_exp_f32_e64 v109, v109 clamp
k_bkaf3:
    v_pk_add_f32 v[102:103], v[102:103], s[56:57]
    v_pk_add_f32 v[106:107], v[106:107], s[56:57]
    v_pk_add_f32 v[104:105], v[104:105], s[56:57]
    v_pk_add_f32 v[108:109], v[108:109], s[56:57]
    v_pk_mul_f32 v[58:59], v[102:103], v[106:107]
    v_pk_mul_f32 v[60:61], v[104:105], v[108:109]
    v_pk_mul_f32 v[66:67], v[106:107], v[50:51]
    s_waitcnt lgkmcnt(0)
    v_rcp_f32 v58, v58
    v_rcp_f32 v59, v59
    v_rcp_f32 v60, v60
    v_rcp_f32 v61, v61
    v_pk_mul_f32 v[68:69], v[108:109], v[52:53]
    v_pk_add_f32 v[62:63], v[102:103], v[106:107]
    v_pk_add_f32 v[64:65], v[104:105], v[108:109]
    v_pk_fma_f32 v[66:67], v[102:103], v[54:55], v[66:67]
    v_pk_fma_f32 v[68:69], v[104:105], v[56:57], v[68:69]
    v_pk_fma_f32 v[34:35], v[62:63], v[58:59], v[34:35]
    v_pk_fma_f32 v[36:37], v[64:65], v[60:61], v[36:37]
    v_pk_fma_f32 v[38:39], v[66:67], v[58:59], v[38:39]
    v_pk_fma_f32 v[40:41], v[68:69], v[60:61], v[40:41]
    ds_write_b128 v18, v[34:37] offset:40960
    ds_write_b128 v18, v[38:41] offset:41216
k_loopdone:
    s_setprio 0
    v_lshrrev_b32 v14, 3, v0
    v_and_b32 v15, 7, v0
    v_lshlrev_b32 v17, 5, v15
    v_lshl_or_b32 v16, v14, 9, v17
    s_cmp_ge_u32 s4, 10
    s_cbranch_scc1 k_nostat
    v_lshlrev_b32 v19, 3, v14
    v_add_u32 v19, 162560, v19
    ds_read_b128 v[36:39], v16 offset:256
    ds_read_b128 v[40:43], v16 offset:272
k_hf:
    ds_read_b32 v125, v20
    ds_read_b64 v[68:69], v19
    v_lshlrev_b32 v21, 2, v15
    v_lshl_or_b32 v21, v14, 8, v21
    v_add_u32 v22, 81408, v17
    s_mov_b32 s20, 0x538637bd
    s_mov_b32 s21, 0x538637bd
    v_lshlrev_b32 v60, 16, v4
    v_and_b32 v64, 0xffff0000, v4
    v_lshlrev_b32 v61, 16, v5
    v_and_b32 v65, 0xffff0000, v5
    v_lshlrev_b32 v62, 16, v6
    v_and_b32 v66, 0xffff0000, v6
    v_lshlrev_b32 v63, 16, v7
    v_and_b32 v67, 0xffff0000, v7
    s_waitcnt lgkmcnt(0)
    v_readfirstlane_b32 s16, v125
    v_cmp_lt_u32 vcc, 0, v68
    s_sub_u32 s99, s99, 1
    s_cbranch_scc1 k_exit
    s_cmp_lt_u32 s16, 64
    s_cbranch_scc1 k_hf
    v_mov_b32 v15, v21
    v_mov_b32 v18, v68
    v_lshl_add_u32 v19, v69, 9, v22
k_nostat:
    s_waitcnt lgkmcnt(0)
    s_barrier
    s_cmp_ge_u32 s4, 10
    s_cbranch_scc1 k_merged
    ds_read_b128 v[20:23], v16 offset:40960
    ds_read_b128 v[24:27], v16 offset:40976
    ds_read_b128 v[28:31], v16 offset:41216
    ds_read_b128 v[32:35], v16 offset:41232
    s_and_b64 exec, exec, vcc
    s_cbranch_execz k_mdone
k_mloop:
    ds_read_b128 v[44:47], v19
    ds_read_b128 v[48:51], v19 offset:16
    ds_read_b128 v[52:55], v19 offset:256
    ds_read_b128 v[56:59], v19 offset:272
    v_cmp_lt_u32 vcc, 1, v18
    v_subrev_u32 v18, 1, v18
    v_subrev_u32 v19, 512, v19
    s_waitcnt lgkmcnt(2)
    v_pk_add_f32 v[20:21], v[20:21], v[44:45]
    v_pk_add_f32 v[22:23], v[22:23], v[46:47]
    v_pk_add_f32 v[24:25], v[24:25], v[48:49]
    v_pk_add_f32 v[26:27], v[26:27], v[50:51]
    s_waitcnt lgkmcnt(0)
    v_pk_add_f32 v[28:29], v[28:29], v[52:53]
    v_pk_add_f32 v[30:31], v[30:31], v[54:55]
    v_pk_add_f32 v[32:33], v[32:33], v[56:57]
    v_pk_add_f32 v[34:35], v[34:35], v[58:59]
    s_and_b64 exec, exec, vcc
    s_cbranch_execnz k_mloop
k_mdone:
    s_mov_b64 exec, -1
    s_waitcnt lgkmcnt(0)
k_merged:
    s_cmp_lg_u32 s88, 0
    s_cbranch_scc1 k_more
    s_cmp_ge_u32 s4, 10
    s_cbranch_scc1 k_ep
    v_pk_add_f32 v[20:21], v[20:21], s[20:21]
    v_pk_add_f32 v[22:23], v[22:23], s[20:21]
    v_pk_add_f32 v[24:25], v[24:25], s[20:21]
    v_pk_add_f32 v[26:27], v[26:27], s[20:21]
    v_rcp_f32 v20, v20
    v_rcp_f32 v21, v21
    v_rcp_f32 v22, v22
    v_rcp_f32 v23, v23
    v_rcp_f32 v24, v24
    v_rcp_f32 v25, v25
    v_rcp_f32 v26, v26
    v_rcp_f32 v27, v27
    s_nop 0
    v_pk_fma_f32 v[28:29], v[28:29], v[20:21], v[36:37]
    v_pk_fma_f32 v[30:31], v[30:31], v[22:23], v[38:39]
    v_pk_fma_f32 v[32:33], v[32:33], v[24:25], v[40:41]
    v_pk_fma_f32 v[34:35], v[34:35], v[26:27], v[42:43]
    v_max_f32 v28, 0, v28
    v_max_f32 v29, 0, v29
    v_max_f32 v30, 0, v30
    v_max_f32 v31, 0, v31
    v_max_f32 v32, 0, v32
    v_max_f32 v33, 0, v33
    v_max_f32 v34, 0, v34
    v_max_f32 v35, 0, v35
    v_pk_add_f32 v[28:29], v[28:29], v[60:61]
    v_pk_add_f32 v[30:31], v[30:31], v[62:63]
    v_pk_add_f32 v[32:33], v[32:33], v[64:65]
    v_pk_add_f32 v[34:35], v[34:35], v[66:67]
    v_cvt_pk_bf16_f32 v20, v28, v32
    buffer_store_dword v20, v15, s[52:55], 0 offen offset:0
    v_cvt_pk_bf16_f32 v21, v29, v33
    buffer_store_dword v21, v15, s[52:55], 0 offen offset:32
    v_cvt_pk_bf16_f32 v22, v30, v34
    buffer_store_dword v22, v15, s[52:55], 0 offen offset:64
    v_cvt_pk_bf16_f32 v23, v31, v35
    buffer_store_dword v23, v15, s[52:55], 0 offen offset:96
k_fin:
k_exit:
    s_endpgm
k_evbf0:
    s_mov_b64 exec, s[84:85]
    ds_write_b128 v18, v[34:37] offset:40960
    ds_write_b128 v18, v[38:41] offset:41216
    v_lshl_add_u32 v18, v17, 9, v23
    s_mov_b64 s[84:85], 0
    ds_read_b128 v[34:37], v18 offset:40960
    ds_read_b128 v[38:41], v18 offset:41216
    s_mov_b64 exec, -1
    s_branch k_bkbf0
k_evbf1:
    s_mov_b64 exec, s[86:87]
    ds_write_b128 v18, v[34:37] offset:40960
    ds_write_b128 v18, v[38:41] offset:41216
    v_lshl_add_u32 v18, v19, 9, v23
    s_mov_b64 s[86:87], 0
    ds_read_b128 v[34:37], v18 offset:40960
    ds_read_b128 v[38:41], v18 offset:41216
    s_mov_b64 exec, -1
    s_branch k_bkbf1
k_evbf2:
    s_mov_b64 exec, s[84:85]
    ds_write_b128 v18, v[34:37] offset:40960
    ds_write_b128 v18, v[38:41] offset:41216
    v_lshl_add_u32 v18, v119, 9, v23
    s_mov_b64 s[84:85], 0
    ds_read_b128 v[34:37], v18 offset:40960
    ds_read_b128 v[38:41], v18 offset:41216
    s_mov_b64 exec, -1
    s_branch k_bkbf2
k_evaf0:
    s_mov_b64 exec, vcc
    v_lshl_add_u32 v118, v19, 9, v23
    s_mov_b64 s[86:87], vcc
    ds_read_b128 v[30:33], v118
    s_mov_b64 exec, -1
    s_branch k_bkaf0
k_evaf1:
    s_mov_b64 exec, vcc
    v_lshl_add_u32 v118, v119, 9, v23
    s_mov_b64 s[84:85], vcc
    ds_read_b128 v[30:33], v118
    s_mov_b64 exec, -1
    s_branch k_bkaf1
k_empty:
    s_mov_b64 exec, s[76:77]
    ds_add_u32 v20, v123
    s_mov_b64 exec, -1
    s_branch k_loopdone
k_ep:
    s_cmp_lg_u32 s4, 15
    s_cbranch_scc1 k_fin
    s_cmp_lg_u32 s2, 0
    s_cbranch_scc1 k_fin
    s_movk_i32 s20, 16384
    s_mov_b32 s21, 0x100000
    s_add_u32 s22, s20, 8192
    s_movk_i32 s23, 677
    v_lshlrev_b32 v14, 7, v3
    s_mov_b64 s[36:37], -1
    s_mov_b64 s[38:39], -1
k_spz:
    s_mov_b64 exec, s[36:37]
    s_cbranch_execz k_spz_a
    buffer_load_dwordx2 v[16:17], v14, s[80:83], s20 offen sc1
k_spz_a:
    s_mov_b64 exec, s[38:39]
    s_cbranch_execz k_spz_b
    buffer_load_dwordx2 v[18:19], v14, s[80:83], s22 offen sc1
k_spz_b:
    s_mov_b64 exec, -1
k_spz_c:
    s_waitcnt vmcnt(0)
    v_cmp_ne_u32 vcc, s101, v16
    v_cmp_ne_u32 s[16:17], s23, v17
    s_or_b64 s[36:37], vcc, s[16:17]
    v_cmp_ne_u32 vcc, s101, v18
    v_cmp_ne_u32 s[16:17], s23, v19
    s_or_b64 s[38:39], vcc, s[16:17]
    s_or_b64 s[16:17], s[36:37], s[38:39]
    s_cbranch_scc0 k_ep1
    s_sleep 2
    s_sub_u32 s21, s21, 1
    s_cbranch_scc0 k_spz
    s_endpgm
k_ep1:
    v_mov_b32 v16, s101
    v_mov_b32 v17, 0
    s_mov_b64 exec, 1
    buffer_store_dword v16, v17, s[28:31], 0 offen sc1
    s_mov_b64 exec, -1
    s_branch k_fin
k_more:
    s_waitcnt vmcnt(0)
    s_cmp_ge_u32 s4, 10
    s_cbranch_scc1 k_more1
    ds_write_b128 v16, v[20:23] offset:40960
    ds_write_b128 v16, v[24:27] offset:40976
    ds_write_b128 v16, v[28:31] offset:41216
    ds_write_b128 v16, v[32:35] offset:41232
k_more1:
    s_waitcnt lgkmcnt(0)
    s_barrier
    v_mov_b64 v[74:75], 0
    v_mov_b64 v[76:77], 0
    v_lshlrev_b32 v78, 4, v0
    v_add_u32 v78, 161536, v78
    v_cmp_gt_u32 vcc, 111, v0
    s_and_saveexec_b64 s[20:21], vcc
    ds_write_b128 v78, v[74:77]
    s_mov_b64 exec, s[20:21]
    s_mul_i32 s20, s79, 12
    v_add_u32 v1, s20, v1
    v_subrev_u32 v2, s79, v2
    s_mov_b32 s100, 0
    s_waitcnt lgkmcnt(0)
    s_barrier
    s_branch k_loadrec
k_shrink:
    s_barrier
    v_mov_b64 v[74:75], 0
    v_mov_b64 v[76:77], 0
    v_lshlrev_b32 v78, 4, v0
    v_add_u32 v78, 161536, v78
    v_cmp_gt_u32 vcc, 111, v0
    s_and_saveexec_b64 s[20:21], vcc
    ds_write_b128 v78, v[74:77]
    s_mov_b64 exec, s[20:21]
    s_mov_b64 s[66:67], 0
    s_mov_b32 s79, 12
    s_waitcnt lgkmcnt(0)
    s_barrier
    ds_write_b32 v15, v123 offset:1664
    s_branch k_rank
k_end:
.section .rodata,"a"
.p2align 6
.amdhsa_kernel standalone__edge_featured_mpnn_gatedgcn__graph_kernel
  .amdhsa_next_free_vgpr 128
  .amdhsa_next_free_sgpr 102
  .amdhsa_accum_offset 128
  .amdhsa_group_segment_fixed_size 0
  .amdhsa_kernarg_size 96
  .amdhsa_user_sgpr_count 2
  .amdhsa_user_sgpr_kernarg_segment_ptr 1
  .amdhsa_system_sgpr_workgroup_id_x 1
  .amdhsa_float_denorm_mode_32 3
  .amdhsa_dx10_clamp 0
.end_amdhsa_kernel
```
